```python
import torch

def _softmax(x, axis=-1):
    return torch.softmax(x, dim=axis)
def _gelu(x):
    return torch.nn.functional.gelu(x, approximate="tanh")
def _silu(x):
    return torch.nn.functional.silu(x)
def _sigmoid(x):
    return torch.sigmoid(x)
def _layernorm(x, axis=-1, eps=1e-5):
    m = x.mean(dim=axis, keepdim=True)
    v = x.var(dim=axis, keepdim=True, unbiased=False)
    return (x - m) / torch.sqrt(v + eps)
def _scatter_add(tgt, idx, src, axis=0):
    return tgt.clone().index_add_(axis, idx, src)
def _segment_sum(src, seg, n):
    out = torch.zeros((n,) + src.shape[1:], dtype=src.dtype)
    return out.index_add_(0, seg, src)
def _pad(x, pw):
    flat = tuple(v for pair in reversed(pw) for v in pair)
    return torch.nn.functional.pad(x, flat)

kernel_name = 'standalone__linear_kernel_performer__prompt'

def setup_inputs():

    _w = (lambda a: (lambda t: t.to(torch.bfloat16) if t.is_floating_point() else t)(torch.as_tensor(a)))
    B, H, S, D = 1, 32, 2048, 128
    M = D
    return {
        "q": _w((lambda *s: torch.randn(*s, dtype=torch.bfloat16) * 0.05)(B, H, S, D)),
        "k": _w((lambda *s: torch.randn(*s, dtype=torch.bfloat16) * 0.8)(B, H, S, D)),
        "v": _w((lambda *s: torch.randn(*s, dtype=torch.bfloat16) * 0.8)(B, H, S, D)),
        "proj": _w((lambda *s: torch.randn(*s, dtype=torch.bfloat16) * 0.8)(M, D)),
    }

def reference(q, k, v, proj):
    B, H, S, D = q.shape
    M = proj.shape[0]
    scale = D ** -0.25
    qs = q * scale
    ks = k * scale
    qw = torch.einsum("bhsd,md->bhsm", qs, proj)
    kw = torch.einsum("bhsd,md->bhsm", ks, proj)
    qn = torch.einsum("bhsd,bhsd->bhs", qs, qs)[..., None] * 0.5
    kn = torch.einsum("bhsd,bhsd->bhs", ks, ks)[..., None] * 0.5
    inv_sqrt_m = M ** -0.5
    phi_q = torch.exp(qw - qn) * inv_sqrt_m
    phi_k = torch.exp(kw - kn) * inv_sqrt_m
    kv = torch.einsum("bhsm,bhsd->bhmd", phi_k, v)
    ksum = torch.einsum("bhsm->bhm", phi_k)
    num = torch.einsum("bhsm,bhmd->bhsd", phi_q, kv)
    den = torch.einsum("bhsm,bhm->bhs", phi_q, ksum)[..., None] + 1e-6
    return num / den
```

```asm
; @launch grid=(256,1,1) block=(512,1,1) lds=163840
.amdgcn_target "amdgcn-amd-amdhsa--gfx950"
.text
.globl standalone__linear_kernel_performer__prompt_kernel
.p2align 8
.type standalone__linear_kernel_performer__prompt_kernel,@function
standalone__linear_kernel_performer__prompt_kernel:
  s_cmp_ge_u32 s2, 256
  s_cbranch_scc1 L_end
  s_load_dwordx2 s[40:41], s[0:1], 24
  s_load_dwordx2 s[20:21], s[0:1], 0
  s_load_dwordx2 s[24:25], s[0:1], 8
  s_load_dwordx2 s[28:29], s[0:1], 16
  s_load_dwordx2 s[32:33], s[0:1], 32
  s_load_dwordx2 s[44:45], s[0:1], 40
  s_load_dwordx2 s[36:37], s[0:1], 48
  v_lshrrev_b32 v1, 6, v0
  v_and_b32 v2, 63, v0
  v_readfirstlane_b32 s3, v1
  v_lshlrev_b32 v3, 2, v0
  v_add_u32 v3, 155648, v3
  v_mov_b32 v4, 0
  s_cmp_lg_u32 s3, 0
  s_cbranch_scc1 L_p1
  ds_write_b32 v3, v4
L_p1:
  s_cmp_ge_u32 s3, 4
  s_cbranch_scc1 L_p2
  s_getpc_b64 s[4:5]
L_pc:
  s_sub_u32 s4, s4, L_pc-standalone__linear_kernel_performer__prompt_kernel
  s_subb_u32 s5, s5, 0
  v_lshlrev_b32 v3, 7, v0
  v_min_u32 v3, L_last-standalone__linear_kernel_performer__prompt_kernel, v3
  global_load_dword v15, v3, s[4:5]
L_p2:
  s_and_b32 s18, s2, 7
  s_lshl_b32 s18, s18, 2
  s_lshr_b32 s19, s2, 3
  s_and_b32 s19, s19, 3
  s_add_u32 s48, s18, s19
  s_lshr_b32 s49, s2, 5
  s_lshl_b32 s67, s48, 19
  s_lshl_b32 s19, s49, 16
  s_add_u32 s18, s67, s19
  s_add_u32 s19, s48, s49
  s_and_b32 s19, s19, 7
  s_lshl_b32 s19, s19, 13
  s_mov_b32 s22, 0x1000000
  s_mov_b32 s23, 0x20000
  s_mov_b32 s26, 0x1000000
  s_mov_b32 s27, 0x20000
  s_mov_b32 s30, 0x1000000
  s_mov_b32 s31, 0x20000
  s_mov_b32 s34, 0x1000000
  s_mov_b32 s35, 0x20000
  s_mov_b32 s38, 0x10000000
  s_mov_b32 s39, 0x20000
  s_mov_b32 s42, 0x8000
  s_mov_b32 s43, 0x20000
  s_mov_b32 s46, 0x100
  s_mov_b32 s47, 0x20000
  s_and_b32 s54, s3, 3
  s_lshl_b32 s55, s54, 11
  s_add_u32 s56, s18, s55
  v_lshrrev_b32 v3, 4, v2
  v_and_b32 v14, 15, v2
  v_xor_b32 v12, v14, v3
  v_lshlrev_b32 v12, 4, v12
  v_lshl_add_u32 v12, v3, 8, v12
  s_lshl_b32 s57, s54, 7
  s_and_b32 s57, s57, 0xc0
  v_xor_b32 v12, s57, v12
  v_xor_b32 v13, 64, v12
  v_lshlrev_b32 v5, 2, v3
  v_xor_b32 v14, v14, v5
  v_lshlrev_b32 v14, 4, v14
  v_lshl_add_u32 v14, v3, 8, v14
  s_waitcnt lgkmcnt(0)
  s_barrier
  s_cmp_lt_u32 s3, 4
  s_cbranch_scc1 L_kw
  s_add_u32 m0, s55, 0
  s_add_u32 s57, s55, 0
  buffer_load_dwordx4 v12, s[40:43], s57 offen lds
  buffer_load_dwordx4 v13, s[40:43], s57 offen offset:1024 lds
  s_add_u32 m0, s55, 8192
  s_add_u32 s57, s55, 8192
  buffer_load_dwordx4 v12, s[40:43], s57 offen lds
  buffer_load_dwordx4 v13, s[40:43], s57 offen offset:1024 lds
  s_add_u32 m0, s55, 16384
  s_add_u32 s57, s55, 16384
  buffer_load_dwordx4 v12, s[40:43], s57 offen lds
  buffer_load_dwordx4 v13, s[40:43], s57 offen offset:1024 lds
  s_add_u32 m0, s55, 24576
  s_add_u32 s57, s55, 24576
  buffer_load_dwordx4 v12, s[40:43], s57 offen lds
  buffer_load_dwordx4 v13, s[40:43], s57 offen offset:1024 lds
  s_add_u32 m0, s55, 98304
  s_add_u32 s57, s19, 0
  s_and_b32 s57, s57, 0xffff
  s_add_u32 s57, s57, s56
  buffer_load_dwordx4 v12, s[24:27], s57 offen nt lds
  buffer_load_dwordx4 v13, s[24:27], s57 offen offset:1024 nt lds
  s_add_u32 m0, s55, 106496
  s_add_u32 s57, s19, 8192
  s_and_b32 s57, s57, 0xffff
  s_add_u32 s57, s57, s56
  buffer_load_dwordx4 v12, s[24:27], s57 offen nt lds
  buffer_load_dwordx4 v13, s[24:27], s57 offen offset:1024 nt lds
  s_setprio 2
  v_mov_b32 v9, 0xbd8293ee
  s_mov_b32 s50, 0x3edb9ada
  s_mov_b32 s60, 0
  s_mov_b32 s69, 100000
  v_and_b32 v3, 31, v2
  v_lshrrev_b32 v4, 5, v2
  v_and_b32 v5, 15, v2
  v_xor_b32 v5, v5, v4
  v_lshlrev_b32 v5, 4, v5
  v_lshl_add_u32 v16, v3, 8, v5
  v_xor_b32 v17, 32, v16
  v_xor_b32 v18, 64, v16
  v_xor_b32 v19, 96, v16
  v_xor_b32 v20, 128, v16
  v_xor_b32 v21, 160, v16
  v_xor_b32 v22, 192, v16
  v_xor_b32 v23, 224, v16
  v_lshlrev_b32 v28, 4, v2
  v_mov_b32 v29, 155648
  v_and_b32 v11, 7, v2
  v_lshlrev_b32 v11, 2, v11
  s_lshl_b32 s57, s54, 7
  s_add_u32 s63, s67, 299008
  s_add_u32 s63, s63, s57
  s_lshl_b32 s57, s54, 10
  s_add_u32 s52, s67, 294912
  s_add_u32 s52, s52, s57
  s_lshl_b32 s58, s54, 13
  s_add_u32 s51, s67, 262144
  s_add_u32 s51, s51, s58
  s_add_u32 s57, s67, s58
  s_lshl_b32 s58, s49, 10
  s_add_u32 s98, s57, s58
  s_add_u32 s100, s51, s58
  s_lshl_b32 s58, s49, 15
  s_add_u32 s99, s57, s58
  s_lshl_b32 s57, s54, 2
  s_add_u32 s57, s57, 155648
  v_mov_b32 v15, s57
  s_add_u32 s57, s55, 98304
  v_add_u32 v24, s57, v28
  v_lshrrev_b32 v3, 4, v2
  v_and_b32 v4, 1, v2
  v_lshl_add_u32 v3, v4, 2, v3
  s_lshl_b32 s57, s54, 5
  s_add_u32 s57, s57, 156672
  v_lshl_add_u32 v25, v3, 2, s57
  s_mov_b32 s4, 0x00030003
  s_mov_b32 s5, 0x00030003
  s_mov_b32 s64, 0xaaaaaaaa
  s_mov_b32 s65, 0xaaaaaaaa
  s_sub_u32 s57, s100, s67
  v_lshl_add_u32 v7, v2, 7, s57
  s_lshl_b32 s57, s49, 7
  s_add_u32 s57, s57, s52
  s_sub_u32 s57, s57, s67
  v_writelane_b32 v7, s57, 8
  s_sub_u32 s57, s63, s67
  v_writelane_b32 v7, s57, 9
  s_waitcnt vmcnt(10)
  v_mov_b32 v254, 1
  s_mov_b64 exec, 1
  ds_write_b32 v15, v254 offset:0
  s_mov_b64 exec, -1
  s_waitcnt vmcnt(8)
  v_mov_b32 v254, 2
  s_mov_b64 exec, 1
  ds_write_b32 v15, v254 offset:0
  s_mov_b64 exec, -1
  s_waitcnt vmcnt(6)
  v_mov_b32 v254, 3
  s_mov_b64 exec, 1
  ds_write_b32 v15, v254 offset:0
  s_mov_b64 exec, -1
  s_add_u32 m0, s55, 65536
  s_add_u32 s57, s19, 0
  s_and_b32 s57, s57, 0xffff
  s_add_u32 s57, s57, s56
  buffer_load_dwordx4 v12, s[20:23], s57 offen nt lds
  buffer_load_dwordx4 v13, s[20:23], s57 offen offset:1024 nt lds
  s_waitcnt vmcnt(6)
  v_mov_b32 v254, 4
  s_mov_b64 exec, 1
  ds_write_b32 v15, v254 offset:0
  s_mov_b64 exec, -1
  s_add_u32 m0, s55, 114688
  s_add_u32 s57, s19, 16384
  s_and_b32 s57, s57, 0xffff
  s_add_u32 s57, s57, s56
  buffer_load_dwordx4 v12, s[24:27], s57 offen nt lds
  buffer_load_dwordx4 v13, s[24:27], s57 offen offset:1024 nt lds
  s_waitcnt vmcnt(6)
  ds_read_b128 v[64:67], v24 offset:0
  ds_read_b128 v[68:71], v24 offset:1024
  s_waitcnt lgkmcnt(0)
  v_dot2_f32_bf16 v72, v64, v64, 0
  v_dot2_f32_bf16 v73, v68, v68, 0
  v_dot2_f32_bf16 v72, v65, v65, v72
  v_dot2_f32_bf16 v73, v69, v69, v73
  v_dot2_f32_bf16 v72, v66, v66, v72
  v_dot2_f32_bf16 v73, v70, v70, v73
  v_dot2_f32_bf16 v72, v67, v67, v72
  v_dot2_f32_bf16 v73, v71, v71, v73
  s_nop 1
  v_add_f32_dpp v72, v72, v72 row_ror:8 row_mask:0xf bank_mask:0xf
  v_add_f32_dpp v73, v73, v73 row_ror:8 row_mask:0xf bank_mask:0xf
  s_nop 0
  v_add_f32_dpp v72, v72, v72 row_ror:4 row_mask:0xf bank_mask:0xf
  v_add_f32_dpp v73, v73, v73 row_ror:4 row_mask:0xf bank_mask:0xf
  s_nop 0
  v_add_f32_dpp v72, v72, v72 row_ror:2 row_mask:0xf bank_mask:0xf
  v_add_f32_dpp v73, v73, v73 row_ror:2 row_mask:0xf bank_mask:0xf
  s_nop 0
  v_add_f32_dpp v72, v72, v72 row_ror:1 row_mask:0xf bank_mask:0xf
  v_add_f32_dpp v73, v73, v73 row_ror:1 row_mask:0xf bank_mask:0xf
  v_cndmask_b32 v72, v72, v73, s[64:65]
  v_fmaak_f32 v72, v72, v9, 0xc0600000
  s_mov_b64 exec, s[4:5]
  ds_write_b32 v25, v72 offset:0
  v_mov_b32 v254, 5
  s_mov_b64 exec, 1
  ds_write_b32 v15, v254 offset:0
  s_mov_b64 exec, -1
  s_add_u32 m0, s55, 32768
  s_add_u32 s57, s19, 0
  s_and_b32 s57, s57, 0xffff
  s_add_u32 s57, s57, s56
  buffer_load_dwordx4 v14, s[28:31], s57 offen nt lds
  buffer_load_dwordx4 v14, s[28:31], s57 offen offset:1024 nt lds
  s_waitcnt vmcnt(6)
  ds_read_b128 v[64:67], v24 offset:8192
  ds_read_b128 v[68:71], v24 offset:9216
  s_waitcnt lgkmcnt(0)
  v_dot2_f32_bf16 v72, v64, v64, 0
  v_dot2_f32_bf16 v73, v68, v68, 0
  v_dot2_f32_bf16 v72, v65, v65, v72
  v_dot2_f32_bf16 v73, v69, v69, v73
  v_dot2_f32_bf16 v72, v66, v66, v72
  v_dot2_f32_bf16 v73, v70, v70, v73
  v_dot2_f32_bf16 v72, v67, v67, v72
  v_dot2_f32_bf16 v73, v71, v71, v73
  s_nop 1
  v_add_f32_dpp v72, v72, v72 row_ror:8 row_mask:0xf bank_mask:0xf
  v_add_f32_dpp v73, v73, v73 row_ror:8 row_mask:0xf bank_mask:0xf
  s_nop 0
  v_add_f32_dpp v72, v72, v72 row_ror:4 row_mask:0xf bank_mask:0xf
  v_add_f32_dpp v73, v73, v73 row_ror:4 row_mask:0xf bank_mask:0xf
  s_nop 0
  v_add_f32_dpp v72, v72, v72 row_ror:2 row_mask:0xf bank_mask:0xf
  v_add_f32_dpp v73, v73, v73 row_ror:2 row_mask:0xf bank_mask:0xf
  s_nop 0
  v_add_f32_dpp v72, v72, v72 row_ror:1 row_mask:0xf bank_mask:0xf
  v_add_f32_dpp v73, v73, v73 row_ror:1 row_mask:0xf bank_mask:0xf
  v_cndmask_b32 v72, v72, v73, s[64:65]
  v_fmaak_f32 v72, v72, v9, 0xc0600000
  s_mov_b64 exec, s[4:5]
  ds_write_b32 v25, v72 offset:128
  v_mov_b32 v254, 6
  s_mov_b64 exec, 1
  ds_write_b32 v15, v254 offset:0
  s_mov_b64 exec, -1
  s_add_u32 m0, s55, 73728
  s_add_u32 s57, s19, 8192
  s_and_b32 s57, s57, 0xffff
  s_add_u32 s57, s57, s56
  buffer_load_dwordx4 v12, s[20:23], s57 offen nt lds
  buffer_load_dwordx4 v13, s[20:23], s57 offen offset:1024 nt lds
  s_waitcnt vmcnt(6)
  v_mov_b32 v254, 7
  s_mov_b64 exec, 1
  ds_write_b32 v15, v254 offset:0
  s_mov_b64 exec, -1
  s_add_u32 m0, s55, 122880
  s_add_u32 s57, s19, 24576
  s_and_b32 s57, s57, 0xffff
  s_add_u32 s57, s57, s56
  buffer_load_dwordx4 v12, s[24:27], s57 offen nt lds
  buffer_load_dwordx4 v13, s[24:27], s57 offen offset:1024 nt lds
  s_waitcnt vmcnt(6)
  ds_read_b128 v[64:67], v24 offset:16384
  ds_read_b128 v[68:71], v24 offset:17408
  s_waitcnt lgkmcnt(0)
  v_dot2_f32_bf16 v72, v64, v64, 0
  v_dot2_f32_bf16 v73, v68, v68, 0
  v_dot2_f32_bf16 v72, v65, v65, v72
  v_dot2_f32_bf16 v73, v69, v69, v73
  v_dot2_f32_bf16 v72, v66, v66, v72
  v_dot2_f32_bf16 v73, v70, v70, v73
  v_dot2_f32_bf16 v72, v67, v67, v72
  v_dot2_f32_bf16 v73, v71, v71, v73
  s_nop 1
  v_add_f32_dpp v72, v72, v72 row_ror:8 row_mask:0xf bank_mask:0xf
  v_add_f32_dpp v73, v73, v73 row_ror:8 row_mask:0xf bank_mask:0xf
  s_nop 0
  v_add_f32_dpp v72, v72, v72 row_ror:4 row_mask:0xf bank_mask:0xf
  v_add_f32_dpp v73, v73, v73 row_ror:4 row_mask:0xf bank_mask:0xf
  s_nop 0
  v_add_f32_dpp v72, v72, v72 row_ror:2 row_mask:0xf bank_mask:0xf
  v_add_f32_dpp v73, v73, v73 row_ror:2 row_mask:0xf bank_mask:0xf
  s_nop 0
  v_add_f32_dpp v72, v72, v72 row_ror:1 row_mask:0xf bank_mask:0xf
  v_add_f32_dpp v73, v73, v73 row_ror:1 row_mask:0xf bank_mask:0xf
  v_cndmask_b32 v72, v72, v73, s[64:65]
  v_fmaak_f32 v72, v72, v9, 0xc0600000
  s_mov_b64 exec, s[4:5]
  ds_write_b32 v25, v72 offset:256
  v_mov_b32 v254, 8
  s_mov_b64 exec, 1
  ds_write_b32 v15, v254 offset:0
  s_mov_b64 exec, -1
  s_add_u32 m0, s55, 40960
  s_add_u32 s57, s19, 8192
  s_and_b32 s57, s57, 0xffff
  s_add_u32 s57, s57, s56
  buffer_load_dwordx4 v14, s[28:31], s57 offen nt lds
  buffer_load_dwordx4 v14, s[28:31], s57 offen offset:1024 nt lds
  s_waitcnt vmcnt(6)
  v_mov_b32 v254, 9
  s_mov_b64 exec, 1
  ds_write_b32 v15, v254 offset:0
  s_mov_b64 exec, -1
  s_add_u32 m0, s55, 81920
  s_add_u32 s57, s19, 16384
  s_and_b32 s57, s57, 0xffff
  s_add_u32 s57, s57, s56
  buffer_load_dwordx4 v12, s[20:23], s57 offen nt lds
  buffer_load_dwordx4 v13, s[20:23], s57 offen offset:1024 nt lds
  s_waitcnt vmcnt(6)
  v_mov_b32 v254, 10
  s_mov_b64 exec, 1
  ds_write_b32 v15, v254 offset:0
  s_mov_b64 exec, -1
  s_add_u32 m0, s55, 131072
  s_add_u32 s57, s19, 32768
  s_and_b32 s57, s57, 0xffff
  s_add_u32 s57, s57, s56
  buffer_load_dwordx4 v12, s[24:27], s57 offen nt lds
  buffer_load_dwordx4 v13, s[24:27], s57 offen offset:1024 nt lds
  s_waitcnt vmcnt(6)
  ds_read_b128 v[64:67], v24 offset:24576
  ds_read_b128 v[68:71], v24 offset:25600
  s_waitcnt lgkmcnt(0)
  v_dot2_f32_bf16 v72, v64, v64, 0
  v_dot2_f32_bf16 v73, v68, v68, 0
  v_dot2_f32_bf16 v72, v65, v65, v72
  v_dot2_f32_bf16 v73, v69, v69, v73
  v_dot2_f32_bf16 v72, v66, v66, v72
  v_dot2_f32_bf16 v73, v70, v70, v73
  v_dot2_f32_bf16 v72, v67, v67, v72
  v_dot2_f32_bf16 v73, v71, v71, v73
  s_nop 1
  v_add_f32_dpp v72, v72, v72 row_ror:8 row_mask:0xf bank_mask:0xf
  v_add_f32_dpp v73, v73, v73 row_ror:8 row_mask:0xf bank_mask:0xf
  s_nop 0
  v_add_f32_dpp v72, v72, v72 row_ror:4 row_mask:0xf bank_mask:0xf
  v_add_f32_dpp v73, v73, v73 row_ror:4 row_mask:0xf bank_mask:0xf
  s_nop 0
  v_add_f32_dpp v72, v72, v72 row_ror:2 row_mask:0xf bank_mask:0xf
  v_add_f32_dpp v73, v73, v73 row_ror:2 row_mask:0xf bank_mask:0xf
  s_nop 0
  v_add_f32_dpp v72, v72, v72 row_ror:1 row_mask:0xf bank_mask:0xf
  v_add_f32_dpp v73, v73, v73 row_ror:1 row_mask:0xf bank_mask:0xf
  v_cndmask_b32 v72, v72, v73, s[64:65]
  v_fmaak_f32 v72, v72, v9, 0xc0600000
  s_mov_b64 exec, s[4:5]
  ds_write_b32 v25, v72 offset:384
  v_mov_b32 v254, 11
  s_mov_b64 exec, 1
  ds_write_b32 v15, v254 offset:0
  s_mov_b64 exec, -1
  s_add_u32 m0, s55, 49152
  s_add_u32 s57, s19, 16384
  s_and_b32 s57, s57, 0xffff
  s_add_u32 s57, s57, s56
  buffer_load_dwordx4 v14, s[28:31], s57 offen nt lds
  buffer_load_dwordx4 v14, s[28:31], s57 offen offset:1024 nt lds
  s_mov_b64 exec, 0x3ff
  buffer_load_dword v74, v7, s[36:39], s67 offen sc1
  s_mov_b64 exec, -1
  s_waitcnt vmcnt(7)
  v_mov_b32 v254, 12
  s_mov_b64 exec, 1
  ds_write_b32 v15, v254 offset:0
  s_mov_b64 exec, -1
  s_add_u32 m0, s55, 90112
  s_add_u32 s57, s19, 24576
  s_and_b32 s57, s57, 0xffff
  s_add_u32 s57, s57, s56
  buffer_load_dwordx4 v12, s[20:23], s57 offen nt lds
  buffer_load_dwordx4 v13, s[20:23], s57 offen offset:1024 nt lds
  s_waitcnt vmcnt(7)
  v_mov_b32 v254, 13
  s_mov_b64 exec, 1
  ds_write_b32 v15, v254 offset:0
  s_mov_b64 exec, -1
  s_add_u32 m0, s55, 139264
  s_add_u32 s57, s19, 40960
  s_and_b32 s57, s57, 0xffff
  s_add_u32 s57, s57, s56
  buffer_load_dwordx4 v12, s[24:27], s57 offen nt lds
  buffer_load_dwordx4 v13, s[24:27], s57 offen offset:1024 nt lds
  s_waitcnt vmcnt(7)
  ds_read_b128 v[64:67], v24 offset:32768
  ds_read_b128 v[68:71], v24 offset:33792
  s_waitcnt lgkmcnt(0)
  v_dot2_f32_bf16 v72, v64, v64, 0
  v_dot2_f32_bf16 v73, v68, v68, 0
  v_dot2_f32_bf16 v72, v65, v65, v72
  v_dot2_f32_bf16 v73, v69, v69, v73
  v_dot2_f32_bf16 v72, v66, v66, v72
  v_dot2_f32_bf16 v73, v70, v70, v73
  v_dot2_f32_bf16 v72, v67, v67, v72
  v_dot2_f32_bf16 v73, v71, v71, v73
  s_nop 1
  v_add_f32_dpp v72, v72, v72 row_ror:8 row_mask:0xf bank_mask:0xf
  v_add_f32_dpp v73, v73, v73 row_ror:8 row_mask:0xf bank_mask:0xf
  s_nop 0
  v_add_f32_dpp v72, v72, v72 row_ror:4 row_mask:0xf bank_mask:0xf
  v_add_f32_dpp v73, v73, v73 row_ror:4 row_mask:0xf bank_mask:0xf
  s_nop 0
  v_add_f32_dpp v72, v72, v72 row_ror:2 row_mask:0xf bank_mask:0xf
  v_add_f32_dpp v73, v73, v73 row_ror:2 row_mask:0xf bank_mask:0xf
  s_nop 0
  v_add_f32_dpp v72, v72, v72 row_ror:1 row_mask:0xf bank_mask:0xf
  v_add_f32_dpp v73, v73, v73 row_ror:1 row_mask:0xf bank_mask:0xf
  v_cndmask_b32 v72, v72, v73, s[64:65]
  v_fmaak_f32 v72, v72, v9, 0xc0600000
  s_mov_b64 exec, s[4:5]
  ds_write_b32 v25, v72 offset:512
  v_mov_b32 v254, 14
  s_mov_b64 exec, 1
  ds_write_b32 v15, v254 offset:0
  s_mov_b64 exec, -1
  s_add_u32 m0, s55, 57344
  s_add_u32 s57, s19, 24576
  s_and_b32 s57, s57, 0xffff
  s_add_u32 s57, s57, s56
  buffer_load_dwordx4 v14, s[28:31], s57 offen nt lds
  buffer_load_dwordx4 v14, s[28:31], s57 offen offset:1024 nt lds
  s_waitcnt vmcnt(7)
  v_mov_b32 v254, 15
  s_mov_b64 exec, 1
  ds_write_b32 v15, v254 offset:0
  s_mov_b64 exec, -1
L_pp1:
  s_nop 0
  ds_read_b128 v[250:253], v29 offset:32
  s_sub_u32 s69, s69, 1
  s_cbranch_scc1 L_ppd2
  s_waitcnt lgkmcnt(0)
  v_min_u32 v250, v250, v251
  v_min3_u32 v250, v250, v252, v253
  s_nop 0
  v_readfirstlane_b32 s61, v250
  s_nop 0
  s_cmp_lt_u32 s61, 2
  s_cbranch_scc1 L_pp1
L_ppd2:
  s_add_u32 m0, s55, 106496
  s_add_u32 s57, s19, 32768
  s_and_b32 s57, s57, 0xffff
  s_add_u32 s57, s57, s56
  buffer_load_dwordx4 v12, s[20:23], s57 offen nt lds
  buffer_load_dwordx4 v13, s[20:23], s57 offen offset:1024 nt lds
  s_waitcnt vmcnt(6)
  v_mov_b32 v254, 16
  s_mov_b64 exec, 1
  ds_write_b32 v15, v254 offset:0
  s_mov_b64 exec, -1
  s_add_u32 m0, s55, 147456
  s_add_u32 s57, s19, 49152
  s_and_b32 s57, s57, 0xffff
  s_add_u32 s57, s57, s56
  buffer_load_dwordx4 v12, s[24:27], s57 offen nt lds
  buffer_load_dwordx4 v13, s[24:27], s57 offen offset:1024 nt lds
  s_waitcnt vmcnt(6)
  ds_read_b128 v[64:67], v24 offset:40960
  ds_read_b128 v[68:71], v24 offset:41984
  s_waitcnt lgkmcnt(0)
  v_dot2_f32_bf16 v72, v64, v64, 0
  v_dot2_f32_bf16 v73, v68, v68, 0
  v_dot2_f32_bf16 v72, v65, v65, v72
  v_dot2_f32_bf16 v73, v69, v69, v73
  v_dot2_f32_bf16 v72, v66, v66, v72
  v_dot2_f32_bf16 v73, v70, v70, v73
  v_dot2_f32_bf16 v72, v67, v67, v72
  v_dot2_f32_bf16 v73, v71, v71, v73
  s_nop 1
  v_add_f32_dpp v72, v72, v72 row_ror:8 row_mask:0xf bank_mask:0xf
  v_add_f32_dpp v73, v73, v73 row_ror:8 row_mask:0xf bank_mask:0xf
  s_nop 0
  v_add_f32_dpp v72, v72, v72 row_ror:4 row_mask:0xf bank_mask:0xf
  v_add_f32_dpp v73, v73, v73 row_ror:4 row_mask:0xf bank_mask:0xf
  s_nop 0
  v_add_f32_dpp v72, v72, v72 row_ror:2 row_mask:0xf bank_mask:0xf
  v_add_f32_dpp v73, v73, v73 row_ror:2 row_mask:0xf bank_mask:0xf
  s_nop 0
  v_add_f32_dpp v72, v72, v72 row_ror:1 row_mask:0xf bank_mask:0xf
  v_add_f32_dpp v73, v73, v73 row_ror:1 row_mask:0xf bank_mask:0xf
  v_cndmask_b32 v72, v72, v73, s[64:65]
  v_fmaak_f32 v72, v72, v9, 0xc0600000
  s_mov_b64 exec, s[4:5]
  ds_write_b32 v25, v72 offset:640
  v_mov_b32 v254, 17
  s_mov_b64 exec, 1
  ds_write_b32 v15, v254 offset:0
  s_mov_b64 exec, -1
L_pp3:
  s_nop 0
  ds_read_b128 v[250:253], v29 offset:0
  s_sub_u32 s69, s69, 1
  s_cbranch_scc1 L_ppd4
  s_waitcnt lgkmcnt(0)
  v_min_u32 v250, v250, v251
  v_min3_u32 v250, v250, v252, v253
  s_nop 0
  v_readfirstlane_b32 s60, v250
  s_nop 0
  s_cmp_lt_u32 s60, 16
  s_cbranch_scc1 L_pp3
L_ppd4:
  s_lshl_b32 s62, s3, 13
  s_add_u32 s62, s62, 32768
  v_add_u32 v240, s62, v16
  v_add_u32 v241, s62, v17
  v_add_u32 v242, s62, v18
  v_add_u32 v243, s62, v19
  v_add_u32 v244, s62, v20
  v_add_u32 v245, s62, v21
  v_add_u32 v246, s62, v22
  v_add_u32 v247, s62, v23
  ds_read_b128 v[160:163], v240
  ds_read_b128 v[164:167], v241
  ds_read_b128 v[168:171], v242
  ds_read_b128 v[172:175], v243
  ds_read_b128 v[176:179], v244
  ds_read_b128 v[180:183], v245
  ds_read_b128 v[184:187], v246
  ds_read_b128 v[188:191], v247
  s_waitcnt lgkmcnt(0)
  v_mov_b32 v254, 1
  s_mov_b64 exec, 1
  ds_write_b32 v15, v254 offset:16
  s_mov_b64 exec, -1
L_pp5:
  s_nop 0
  ds_read_b128 v[250:253], v29 offset:16
  s_sub_u32 s69, s69, 1
  s_cbranch_scc1 L_ppd6
  s_waitcnt lgkmcnt(0)
  v_min_u32 v250, v250, v251
  v_min3_u32 v250, v250, v252, v253
  s_nop 0
  v_readfirstlane_b32 s61, v250
  s_nop 0
  s_cmp_lt_u32 s61, 1
  s_cbranch_scc1 L_pp5
L_ppd6:
  s_add_u32 m0, s55, 65536
  s_add_u32 s57, s19, 32768
  s_and_b32 s57, s57, 0xffff
  s_add_u32 s57, s57, s56
  buffer_load_dwordx4 v14, s[28:31], s57 offen nt lds
  buffer_load_dwordx4 v14, s[28:31], s57 offen offset:1024 nt lds
  s_waitcnt vmcnt(6)
  v_mov_b32 v254, 18
  s_mov_b64 exec, 1
  ds_write_b32 v15, v254 offset:0
  s_mov_b64 exec, -1
  s_add_u32 m0, s55, 114688
  s_add_u32 s57, s19, 40960
  s_and_b32 s57, s57, 0xffff
  s_add_u32 s57, s57, s56
  buffer_load_dwordx4 v12, s[20:23], s57 offen nt lds
  buffer_load_dwordx4 v13, s[20:23], s57 offen offset:1024 nt lds
  s_waitcnt vmcnt(6)
  v_mov_b32 v254, 19
  s_mov_b64 exec, 1
  ds_write_b32 v15, v254 offset:0
  s_mov_b64 exec, -1
L_pp7:
  s_nop 0
  ds_read_b128 v[250:253], v29 offset:32
  s_sub_u32 s69, s69, 1
  s_cbranch_scc1 L_ppd8
  s_waitcnt lgkmcnt(0)
  v_min_u32 v250, v250, v251
  v_min3_u32 v250, v250, v252, v253
  s_nop 0
  v_readfirstlane_b32 s61, v250
  s_nop 0
  s_cmp_lt_u32 s61, 1
  s_cbranch_scc1 L_pp7
L_ppd8:
  s_add_u32 m0, s55, 98304
  s_add_u32 s57, s19, 57344
  s_and_b32 s57, s57, 0xffff
  s_add_u32 s57, s57, s56
  buffer_load_dwordx4 v12, s[24:27], s57 offen nt lds
  buffer_load_dwordx4 v13, s[24:27], s57 offen offset:1024 nt lds
  s_waitcnt vmcnt(6)
  ds_read_b128 v[64:67], v24 offset:49152
  ds_read_b128 v[68:71], v24 offset:50176
  s_waitcnt lgkmcnt(0)
  v_dot2_f32_bf16 v72, v64, v64, 0
  v_dot2_f32_bf16 v73, v68, v68, 0
  v_dot2_f32_bf16 v72, v65, v65, v72
  v_dot2_f32_bf16 v73, v69, v69, v73
  v_dot2_f32_bf16 v72, v66, v66, v72
  v_dot2_f32_bf16 v73, v70, v70, v73
  v_dot2_f32_bf16 v72, v67, v67, v72
  v_dot2_f32_bf16 v73, v71, v71, v73
  s_nop 1
  v_add_f32_dpp v72, v72, v72 row_ror:8 row_mask:0xf bank_mask:0xf
  v_add_f32_dpp v73, v73, v73 row_ror:8 row_mask:0xf bank_mask:0xf
  s_nop 0
  v_add_f32_dpp v72, v72, v72 row_ror:4 row_mask:0xf bank_mask:0xf
  v_add_f32_dpp v73, v73, v73 row_ror:4 row_mask:0xf bank_mask:0xf
  s_nop 0
  v_add_f32_dpp v72, v72, v72 row_ror:2 row_mask:0xf bank_mask:0xf
  v_add_f32_dpp v73, v73, v73 row_ror:2 row_mask:0xf bank_mask:0xf
  s_nop 0
  v_add_f32_dpp v72, v72, v72 row_ror:1 row_mask:0xf bank_mask:0xf
  v_add_f32_dpp v73, v73, v73 row_ror:1 row_mask:0xf bank_mask:0xf
  v_cndmask_b32 v72, v72, v73, s[64:65]
  v_fmaak_f32 v72, v72, v9, 0xc0600000
  s_mov_b64 exec, s[4:5]
  ds_write_b32 v25, v72 offset:768
  v_mov_b32 v254, 20
  s_mov_b64 exec, 1
  ds_write_b32 v15, v254 offset:0
  s_mov_b64 exec, -1
  s_add_u32 m0, s55, 73728
  s_add_u32 s57, s19, 40960
  s_and_b32 s57, s57, 0xffff
  s_add_u32 s57, s57, s56
  buffer_load_dwordx4 v14, s[28:31], s57 offen nt lds
  buffer_load_dwordx4 v14, s[28:31], s57 offen offset:1024 nt lds
  s_waitcnt vmcnt(6)
  v_mov_b32 v254, 21
  s_mov_b64 exec, 1
  ds_write_b32 v15, v254 offset:0
  s_mov_b64 exec, -1
L_pp9:
  s_nop 0
  ds_read_b128 v[250:253], v29 offset:32
  s_sub_u32 s69, s69, 1
  s_cbranch_scc1 L_ppd10
  s_waitcnt lgkmcnt(0)
  v_min_u32 v250, v250, v251
  v_min3_u32 v250, v250, v252, v253
  s_nop 0
  v_readfirstlane_b32 s61, v250
  s_nop 0
  s_cmp_lt_u32 s61, 3
  s_cbranch_scc1 L_pp9
L_ppd10:
  s_add_u32 m0, s55, 122880
  s_add_u32 s57, s19, 49152
  s_and_b32 s57, s57, 0xffff
  s_add_u32 s57, s57, s56
  buffer_load_dwordx4 v12, s[20:23], s57 offen nt lds
  buffer_load_dwordx4 v13, s[20:23], s57 offen offset:1024 nt lds
  s_waitcnt vmcnt(6)
  v_mov_b32 v254, 22
  s_mov_b64 exec, 1
  ds_write_b32 v15, v254 offset:0
  s_mov_b64 exec, -1
  s_add_u32 m0, s55, 81920
  s_add_u32 s57, s19, 49152
  s_and_b32 s57, s57, 0xffff
  s_add_u32 s57, s57, s56
  buffer_load_dwordx4 v14, s[28:31], s57 offen nt lds
  buffer_load_dwordx4 v14, s[28:31], s57 offen offset:1024 nt lds
  s_waitcnt vmcnt(6)
  ds_read_b128 v[64:67], v24 offset:0
  ds_read_b128 v[68:71], v24 offset:1024
  s_waitcnt lgkmcnt(0)
  v_dot2_f32_bf16 v72, v64, v64, 0
  v_dot2_f32_bf16 v73, v68, v68, 0
  v_dot2_f32_bf16 v72, v65, v65, v72
  v_dot2_f32_bf16 v73, v69, v69, v73
  v_dot2_f32_bf16 v72, v66, v66, v72
  v_dot2_f32_bf16 v73, v70, v70, v73
  v_dot2_f32_bf16 v72, v67, v67, v72
  v_dot2_f32_bf16 v73, v71, v71, v73
  s_nop 1
  v_add_f32_dpp v72, v72, v72 row_ror:8 row_mask:0xf bank_mask:0xf
  v_add_f32_dpp v73, v73, v73 row_ror:8 row_mask:0xf bank_mask:0xf
  s_nop 0
  v_add_f32_dpp v72, v72, v72 row_ror:4 row_mask:0xf bank_mask:0xf
  v_add_f32_dpp v73, v73, v73 row_ror:4 row_mask:0xf bank_mask:0xf
  s_nop 0
  v_add_f32_dpp v72, v72, v72 row_ror:2 row_mask:0xf bank_mask:0xf
  v_add_f32_dpp v73, v73, v73 row_ror:2 row_mask:0xf bank_mask:0xf
  s_nop 0
  v_add_f32_dpp v72, v72, v72 row_ror:1 row_mask:0xf bank_mask:0xf
  v_add_f32_dpp v73, v73, v73 row_ror:1 row_mask:0xf bank_mask:0xf
  v_cndmask_b32 v72, v72, v73, s[64:65]
  v_fmaak_f32 v72, v72, v9, 0xc0600000
  s_mov_b64 exec, s[4:5]
  ds_write_b32 v25, v72 offset:896
  v_mov_b32 v254, 23
  s_mov_b64 exec, 1
  ds_write_b32 v15, v254 offset:0
  s_mov_b64 exec, -1
  s_add_u32 m0, s55, 131072
  s_add_u32 s57, s19, 57344
  s_and_b32 s57, s57, 0xffff
  s_add_u32 s57, s57, s56
  buffer_load_dwordx4 v12, s[20:23], s57 offen nt lds
  buffer_load_dwordx4 v13, s[20:23], s57 offen offset:1024 nt lds
  s_waitcnt vmcnt(6)
  v_mov_b32 v254, 24
  s_mov_b64 exec, 1
  ds_write_b32 v15, v254 offset:0
  s_mov_b64 exec, -1
  s_add_u32 m0, s55, 90112
  s_add_u32 s57, s19, 57344
  s_and_b32 s57, s57, 0xffff
  s_add_u32 s57, s57, s56
  buffer_load_dwordx4 v14, s[28:31], s57 offen nt lds
  buffer_load_dwordx4 v14, s[28:31], s57 offen offset:1024 nt lds
  s_waitcnt vmcnt(6)
  v_mov_b32 v254, 25
  s_mov_b64 exec, 1
  ds_write_b32 v15, v254 offset:0
  s_mov_b64 exec, -1
  s_waitcnt vmcnt(4)
  v_mov_b32 v254, 26
  s_mov_b64 exec, 1
  ds_write_b32 v15, v254 offset:0
  s_mov_b64 exec, -1
  s_waitcnt vmcnt(2)
  v_mov_b32 v254, 27
  s_mov_b64 exec, 1
  ds_write_b32 v15, v254 offset:0
  s_mov_b64 exec, -1
  s_waitcnt vmcnt(0)
  v_mov_b32 v254, 28
  s_mov_b64 exec, 1
  ds_write_b32 v15, v254 offset:0
  s_mov_b64 exec, -1
  s_setprio 0
  ds_read_b128 v[96:99], v16 offset:0
  ds_read_b128 v[100:103], v17 offset:0
  ds_read_b128 v[104:107], v18 offset:0
  ds_read_b128 v[108:111], v19 offset:0
  ds_read_b128 v[112:115], v20 offset:0
  ds_read_b128 v[116:119], v21 offset:0
  ds_read_b128 v[120:123], v22 offset:0
  ds_read_b128 v[124:127], v23 offset:0
  v_dot2_f32_bf16 v4, v160, v160, 0
  v_dot2_f32_bf16 v5, v161, v161, 0
  v_dot2_f32_bf16 v4, v162, v162, v4
  v_dot2_f32_bf16 v5, v163, v163, v5
  v_dot2_f32_bf16 v4, v164, v164, v4
  v_dot2_f32_bf16 v5, v165, v165, v5
  v_dot2_f32_bf16 v4, v166, v166, v4
  v_dot2_f32_bf16 v5, v167, v167, v5
  v_dot2_f32_bf16 v4, v168, v168, v4
  v_dot2_f32_bf16 v5, v169, v169, v5
  v_dot2_f32_bf16 v4, v170, v170, v4
  v_dot2_f32_bf16 v5, v171, v171, v5
  v_dot2_f32_bf16 v4, v172, v172, v4
  v_dot2_f32_bf16 v5, v173, v173, v5
  v_dot2_f32_bf16 v4, v174, v174, v4
  v_dot2_f32_bf16 v5, v175, v175, v5
  v_dot2_f32_bf16 v4, v176, v176, v4
  v_dot2_f32_bf16 v5, v177, v177, v5
  v_dot2_f32_bf16 v4, v178, v178, v4
  v_dot2_f32_bf16 v5, v179, v179, v5
  v_dot2_f32_bf16 v4, v180, v180, v4
  v_dot2_f32_bf16 v5, v181, v181, v5
  v_dot2_f32_bf16 v4, v182, v182, v4
  v_dot2_f32_bf16 v5, v183, v183, v5
  v_dot2_f32_bf16 v4, v184, v184, v4
  v_dot2_f32_bf16 v5, v185, v185, v5
  v_dot2_f32_bf16 v4, v186, v186, v4
  v_dot2_f32_bf16 v5, v187, v187, v5
  v_dot2_f32_bf16 v4, v188, v188, v4
  v_dot2_f32_bf16 v5, v189, v189, v5
  v_dot2_f32_bf16 v4, v190, v190, v4
  v_dot2_f32_bf16 v5, v191, v191, v5
  s_nop 2
  v_add_f32 v4, v4, v5
  v_mov_b32 v5, v4
  s_nop 1
  v_permlane32_swap_b32 v4, v5
  v_add_f32 v4, v4, v5
  v_fmaak_f32 v8, v4, v9, 0xc0600000
  s_waitcnt lgkmcnt(7)
  v_mfma_f32_32x32x16_bf16 v[192:207], v[96:99], v[160:163], 0
  ds_read_b128 v[128:131], v16 offset:8192
  s_waitcnt lgkmcnt(7)
  v_mfma_f32_32x32x16_bf16 v[192:207], v[100:103], v[164:167], v[192:207]
  ds_read_b128 v[132:135], v17 offset:8192
  s_waitcnt lgkmcnt(7)
  v_mfma_f32_32x32x16_bf16 v[192:207], v[104:107], v[168:171], v[192:207]
  ds_read_b128 v[136:139], v18 offset:8192
  s_waitcnt lgkmcnt(7)
  v_mfma_f32_32x32x16_bf16 v[192:207], v[108:111], v[172:175], v[192:207]
  ds_read_b128 v[140:143], v19 offset:8192
  s_waitcnt lgkmcnt(7)
  v_mfma_f32_32x32x16_bf16 v[192:207], v[112:115], v[176:179], v[192:207]
  ds_read_b128 v[144:147], v20 offset:8192
  s_waitcnt lgkmcnt(7)
  v_mfma_f32_32x32x16_bf16 v[192:207], v[116:119], v[180:183], v[192:207]
  ds_read_b128 v[148:151], v21 offset:8192
  s_waitcnt lgkmcnt(7)
  v_mfma_f32_32x32x16_bf16 v[192:207], v[120:123], v[184:187], v[192:207]
  ds_read_b128 v[152:155], v22 offset:8192
  s_waitcnt lgkmcnt(7)
  v_mfma_f32_32x32x16_bf16 v[192:207], v[124:127], v[188:191], v[192:207]
  ds_read_b128 v[156:159], v23 offset:8192
  s_waitcnt lgkmcnt(7)
  v_mfma_f32_32x32x16_bf16 v[208:223], v[128:131], v[160:163], 0
  ds_read_b128 v[96:99], v16 offset:16384
  s_waitcnt lgkmcnt(7)
  v_mfma_f32_32x32x16_bf16 v[208:223], v[132:135], v[164:167], v[208:223]
  ds_read_b128 v[100:103], v17 offset:16384
  s_nop 4
  v_fma_f32 v192, v192, s50, v8
  v_fma_f32 v193, v193, s50, v8
  v_exp_f32 v192, v192
  v_fma_f32 v194, v194, s50, v8
  s_waitcnt lgkmcnt(7)
  v_mfma_f32_32x32x16_bf16 v[208:223], v[136:139], v[168:171], v[208:223]
  ds_read_b128 v[104:107], v18 offset:16384
  v_exp_f32 v193, v193
  v_fma_f32 v195, v195, s50, v8
  v_exp_f32 v194, v194
  v_cvt_pk_bf16_f32 v32, v192, v193
  s_waitcnt lgkmcnt(7)
  v_mfma_f32_32x32x16_bf16 v[208:223], v[140:143], v[172:175], v[208:223]
  ds_read_b128 v[108:111], v19 offset:16384
  v_fma_f32 v196, v196, s50, v8
  v_exp_f32 v195, v195
  v_fma_f32 v197, v197, s50, v8
  v_exp_f32 v196, v196
  s_waitcnt lgkmcnt(7)
  v_mfma_f32_32x32x16_bf16 v[208:223], v[144:147], v[176:179], v[208:223]
  ds_read_b128 v[112:115], v20 offset:16384
  v_cvt_pk_bf16_f32 v33, v194, v195
  v_fma_f32 v198, v198, s50, v8
  v_exp_f32 v197, v197
  v_fma_f32 v199, v199, s50, v8
  s_waitcnt lgkmcnt(7)
  v_mfma_f32_32x32x16_bf16 v[208:223], v[148:151], v[180:183], v[208:223]
  ds_read_b128 v[116:119], v21 offset:16384
  v_exp_f32 v198, v198
  v_cvt_pk_bf16_f32 v34, v196, v197
  v_fma_f32 v200, v200, s50, v8
  v_exp_f32 v199, v199
  s_waitcnt lgkmcnt(7)
  v_mfma_f32_32x32x16_bf16 v[208:223], v[152:155], v[184:187], v[208:223]
  ds_read_b128 v[120:123], v22 offset:16384
  v_fma_f32 v201, v201, s50, v8
  v_exp_f32 v200, v200
  v_cvt_pk_bf16_f32 v35, v198, v199
  v_fma_f32 v202, v202, s50, v8
  s_waitcnt lgkmcnt(7)
  v_mfma_f32_32x32x16_bf16 v[208:223], v[156:159], v[188:191], v[208:223]
  ds_read_b128 v[124:127], v23 offset:16384
  v_exp_f32 v201, v201
  v_fma_f32 v203, v203, s50, v8
  v_exp_f32 v202, v202
  v_cvt_pk_bf16_f32 v36, v200, v201
  v_fma_f32 v204, v204, s50, v8
  v_exp_f32 v203, v203
  v_fma_f32 v205, v205, s50, v8
  v_exp_f32 v204, v204
  v_cvt_pk_bf16_f32 v37, v202, v203
  v_fma_f32 v206, v206, s50, v8
  v_exp_f32 v205, v205
  v_fma_f32 v207, v207, s50, v8
  v_exp_f32 v206, v206
  v_cvt_pk_bf16_f32 v38, v204, v205
  v_exp_f32 v207, v207
  s_nop 0
  v_cvt_pk_bf16_f32 v39, v206, v207
  s_waitcnt lgkmcnt(7)
  v_mfma_f32_32x32x16_bf16 v[192:207], v[96:99], v[160:163], 0
  ds_read_b128 v[128:131], v16 offset:24576
  s_waitcnt lgkmcnt(7)
  v_mfma_f32_32x32x16_bf16 v[192:207], v[100:103], v[164:167], v[192:207]
  ds_read_b128 v[132:135], v17 offset:24576
  v_fma_f32 v208, v208, s50, v8
  v_fma_f32 v209, v209, s50, v8
  v_exp_f32 v208, v208
  v_fma_f32 v210, v210, s50, v8
  s_waitcnt lgkmcnt(7)
  v_mfma_f32_32x32x16_bf16 v[192:207], v[104:107], v[168:171], v[192:207]
  ds_read_b128 v[136:139], v18 offset:24576
  v_exp_f32 v209, v209
  v_fma_f32 v211, v211, s50, v8
  v_exp_f32 v210, v210
  v_cvt_pk_bf16_f32 v40, v208, v209
  s_waitcnt lgkmcnt(7)
  v_mfma_f32_32x32x16_bf16 v[192:207], v[108:111], v[172:175], v[192:207]
  ds_read_b128 v[140:143], v19 offset:24576
  v_fma_f32 v212, v212, s50, v8
  v_exp_f32 v211, v211
  v_fma_f32 v213, v213, s50, v8
  v_exp_f32 v212, v212
  s_waitcnt lgkmcnt(7)
  v_mfma_f32_32x32x16_bf16 v[192:207], v[112:115], v[176:179], v[192:207]
  ds_read_b128 v[144:147], v20 offset:24576
  v_cvt_pk_bf16_f32 v41, v210, v211
  v_fma_f32 v214, v214, s50, v8
  v_exp_f32 v213, v213
  v_fma_f32 v215, v215, s50, v8
  s_waitcnt lgkmcnt(7)
  v_mfma_f32_32x32x16_bf16 v[192:207], v[116:119], v[180:183], v[192:207]
  ds_read_b128 v[148:151], v21 offset:24576
  v_exp_f32 v214, v214
  v_cvt_pk_bf16_f32 v42, v212, v213
  v_fma_f32 v216, v216, s50, v8
  v_exp_f32 v215, v215
  s_waitcnt lgkmcnt(7)
  v_mfma_f32_32x32x16_bf16 v[192:207], v[120:123], v[184:187], v[192:207]
  ds_read_b128 v[152:155], v22 offset:24576
  v_fma_f32 v217, v217, s50, v8
  v_exp_f32 v216, v216
  v_cvt_pk_bf16_f32 v43, v214, v215
  v_fma_f32 v218, v218, s50, v8
  s_waitcnt lgkmcnt(7)
  v_mfma_f32_32x32x16_bf16 v[192:207], v[124:127], v[188:191], v[192:207]
  ds_read_b128 v[156:159], v23 offset:24576
  v_exp_f32 v217, v217
  v_fma_f32 v219, v219, s50, v8
  v_exp_f32 v218, v218
  v_cvt_pk_bf16_f32 v44, v216, v217
  v_fma_f32 v220, v220, s50, v8
  v_exp_f32 v219, v219
  v_fma_f32 v221, v221, s50, v8
  v_exp_f32 v220, v220
  v_cvt_pk_bf16_f32 v45, v218, v219
  v_fma_f32 v222, v222, s50, v8
  v_exp_f32 v221, v221
  v_fma_f32 v223, v223, s50, v8
  v_exp_f32 v222, v222
  v_cvt_pk_bf16_f32 v46, v220, v221
  v_exp_f32 v223, v223
  s_nop 0
  v_cvt_pk_bf16_f32 v47, v222, v223
  s_waitcnt lgkmcnt(7)
  v_mfma_f32_32x32x16_bf16 v[208:223], v[128:131], v[160:163], 0
  s_waitcnt lgkmcnt(6)
  v_mfma_f32_32x32x16_bf16 v[208:223], v[132:135], v[164:167], v[208:223]
  v_fma_f32 v192, v192, s50, v8
  v_fma_f32 v193, v193, s50, v8
  v_exp_f32 v192, v192
  v_fma_f32 v194, v194, s50, v8
  v_exp_f32 v193, v193
  s_waitcnt lgkmcnt(5)
  v_mfma_f32_32x32x16_bf16 v[208:223], v[136:139], v[168:171], v[208:223]
  v_fma_f32 v195, v195, s50, v8
  v_exp_f32 v194, v194
  v_cvt_pk_bf16_f32 v48, v192, v193
  v_fma_f32 v196, v196, s50, v8
  v_exp_f32 v195, v195
  s_waitcnt lgkmcnt(4)
  v_mfma_f32_32x32x16_bf16 v[208:223], v[140:143], v[172:175], v[208:223]
  v_fma_f32 v197, v197, s50, v8
  v_exp_f32 v196, v196
  v_cvt_pk_bf16_f32 v49, v194, v195
  v_fma_f32 v198, v198, s50, v8
  v_exp_f32 v197, v197
  s_waitcnt lgkmcnt(3)
  v_mfma_f32_32x32x16_bf16 v[208:223], v[144:147], v[176:179], v[208:223]
  v_fma_f32 v199, v199, s50, v8
  v_exp_f32 v198, v198
  v_cvt_pk_bf16_f32 v50, v196, v197
  v_fma_f32 v200, v200, s50, v8
  v_exp_f32 v199, v199
  s_waitcnt lgkmcnt(2)
  v_mfma_f32_32x32x16_bf16 v[208:223], v[148:151], v[180:183], v[208:223]
  v_fma_f32 v201, v201, s50, v8
  v_exp_f32 v200, v200
  v_cvt_pk_bf16_f32 v51, v198, v199
  v_fma_f32 v202, v202, s50, v8
  v_exp_f32 v201, v201
  s_waitcnt lgkmcnt(1)
  v_mfma_f32_32x32x16_bf16 v[208:223], v[152:155], v[184:187], v[208:223]
  v_fma_f32 v203, v203, s50, v8
  v_exp_f32 v202, v202
  v_cvt_pk_bf16_f32 v52, v200, v201
  v_fma_f32 v204, v204, s50, v8
  v_exp_f32 v203, v203
  s_waitcnt lgkmcnt(0)
  v_mfma_f32_32x32x16_bf16 v[208:223], v[156:159], v[188:191], v[208:223]
  v_fma_f32 v205, v205, s50, v8
  v_exp_f32 v204, v204
  v_cvt_pk_bf16_f32 v53, v202, v203
  v_fma_f32 v206, v206, s50, v8
  v_exp_f32 v205, v205
  v_fma_f32 v207, v207, s50, v8
  v_exp_f32 v206, v206
  v_cvt_pk_bf16_f32 v54, v204, v205
  v_exp_f32 v207, v207
  s_nop 0
  v_cvt_pk_bf16_f32 v55, v206, v207
  s_nop 0
  v_fma_f32 v208, v208, s50, v8
  v_fma_f32 v209, v209, s50, v8
  v_exp_f32 v208, v208
  v_fma_f32 v210, v210, s50, v8
  v_exp_f32 v209, v209
  v_fma_f32 v211, v211, s50, v8
  v_exp_f32 v210, v210
  v_cvt_pk_bf16_f32 v56, v208, v209
  v_fma_f32 v212, v212, s50, v8
  v_exp_f32 v211, v211
  v_fma_f32 v213, v213, s50, v8
  v_exp_f32 v212, v212
  v_cvt_pk_bf16_f32 v57, v210, v211
  v_fma_f32 v214, v214, s50, v8
  v_exp_f32 v213, v213
  v_fma_f32 v215, v215, s50, v8
  v_exp_f32 v214, v214
  v_cvt_pk_bf16_f32 v58, v212, v213
  v_fma_f32 v216, v216, s50, v8
  v_exp_f32 v215, v215
  v_fma_f32 v217, v217, s50, v8
  v_exp_f32 v216, v216
  v_cvt_pk_bf16_f32 v59, v214, v215
  v_fma_f32 v218, v218, s50, v8
  v_exp_f32 v217, v217
  v_fma_f32 v219, v219, s50, v8
  v_exp_f32 v218, v218
  v_cvt_pk_bf16_f32 v60, v216, v217
  v_fma_f32 v220, v220, s50, v8
  v_exp_f32 v219, v219
  v_fma_f32 v221, v221, s50, v8
  v_exp_f32 v220, v220
  v_cvt_pk_bf16_f32 v61, v218, v219
  v_fma_f32 v222, v222, s50, v8
  v_exp_f32 v221, v221
  v_fma_f32 v223, v223, s50, v8
  v_exp_f32 v222, v222
  v_cvt_pk_bf16_f32 v62, v220, v221
  v_exp_f32 v223, v223
  s_nop 0
  v_cvt_pk_bf16_f32 v63, v222, v223
L_pp11:
  s_nop 0
  ds_read_b128 v[250:253], v29 offset:32
  s_sub_u32 s69, s69, 1
  s_cbranch_scc1 L_ppd12
  s_waitcnt lgkmcnt(0)
  v_min_u32 v250, v250, v251
  v_min3_u32 v250, v250, v252, v253
  s_nop 0
  v_readfirstlane_b32 s61, v250
  s_nop 0
  s_cmp_lt_u32 s61, 4
  s_cbranch_scc1 L_pp11
L_ppd12:
  s_lshl_b32 s62, s54, 13
  s_add_u32 s62, s62, 32768
  v_add_u32 v26, s62, v28
  ds_write_b128 v26, v[32:35] offset:0
  ds_write_b128 v26, v[36:39] offset:1024
  ds_write_b128 v26, v[40:43] offset:2048
  ds_write_b128 v26, v[44:47] offset:3072
  ds_write_b128 v26, v[48:51] offset:4096
  ds_write_b128 v26, v[52:55] offset:5120
  ds_write_b128 v26, v[56:59] offset:6144
  ds_write_b128 v26, v[60:63] offset:7168
L_pp13:
  s_nop 0
  ds_read_b128 v[250:253], v29 offset:0
  s_sub_u32 s69, s69, 1
  s_cbranch_scc1 L_ppd14
  s_waitcnt lgkmcnt(0)
  v_min_u32 v250, v250, v251
  v_min3_u32 v250, v250, v252, v253
  s_nop 0
  v_readfirstlane_b32 s60, v250
  s_nop 0
  s_cmp_lt_u32 s60, 28
  s_cbranch_scc1 L_pp13
L_ppd14:
  s_lshl_b32 s62, s3, 13
  s_add_u32 s62, s62, 73728
  v_add_u32 v240, s62, v16
  v_add_u32 v241, s62, v17
  v_add_u32 v242, s62, v18
  v_add_u32 v243, s62, v19
  v_add_u32 v244, s62, v20
  v_add_u32 v245, s62, v21
  v_add_u32 v246, s62, v22
  v_add_u32 v247, s62, v23
  ds_read_b128 v[160:163], v240
  ds_read_b128 v[164:167], v241
  ds_read_b128 v[168:171], v242
  ds_read_b128 v[172:175], v243
  ds_read_b128 v[176:179], v244
  ds_read_b128 v[180:183], v245
  ds_read_b128 v[184:187], v246
  ds_read_b128 v[188:191], v247
  ds_read_b128 v[96:99], v16 offset:0
  ds_read_b128 v[100:103], v17 offset:0
  ds_read_b128 v[104:107], v18 offset:0
  ds_read_b128 v[108:111], v19 offset:0
  ds_read_b128 v[112:115], v20 offset:0
  ds_read_b128 v[116:119], v21 offset:0
  ds_read_b128 v[120:123], v22 offset:0
  s_waitcnt lgkmcnt(7)
  ds_read_b128 v[124:127], v23 offset:0
  v_dot2_f32_bf16 v4, v160, v160, 0
  v_dot2_f32_bf16 v5, v161, v161, 0
  v_dot2_f32_bf16 v4, v162, v162, v4
  v_dot2_f32_bf16 v5, v163, v163, v5
  v_dot2_f32_bf16 v4, v164, v164, v4
  v_dot2_f32_bf16 v5, v165, v165, v5
  v_dot2_f32_bf16 v4, v166, v166, v4
  v_dot2_f32_bf16 v5, v167, v167, v5
  v_dot2_f32_bf16 v4, v168, v168, v4
  v_dot2_f32_bf16 v5, v169, v169, v5
  v_dot2_f32_bf16 v4, v170, v170, v4
  v_dot2_f32_bf16 v5, v171, v171, v5
  v_dot2_f32_bf16 v4, v172, v172, v4
  v_dot2_f32_bf16 v5, v173, v173, v5
  v_dot2_f32_bf16 v4, v174, v174, v4
  v_dot2_f32_bf16 v5, v175, v175, v5
  v_dot2_f32_bf16 v4, v176, v176, v4
  v_dot2_f32_bf16 v5, v177, v177, v5
  v_dot2_f32_bf16 v4, v178, v178, v4
  v_dot2_f32_bf16 v5, v179, v179, v5
  v_dot2_f32_bf16 v4, v180, v180, v4
  v_dot2_f32_bf16 v5, v181, v181, v5
  v_dot2_f32_bf16 v4, v182, v182, v4
  v_dot2_f32_bf16 v5, v183, v183, v5
  v_dot2_f32_bf16 v4, v184, v184, v4
  v_dot2_f32_bf16 v5, v185, v185, v5
  v_dot2_f32_bf16 v4, v186, v186, v4
  v_dot2_f32_bf16 v5, v187, v187, v5
  v_dot2_f32_bf16 v4, v188, v188, v4
  v_dot2_f32_bf16 v5, v189, v189, v5
  v_dot2_f32_bf16 v4, v190, v190, v4
  v_dot2_f32_bf16 v5, v191, v191, v5
  s_nop 2
  v_add_f32 v4, v4, v5
  v_mov_b32 v5, v4
  s_nop 1
  v_permlane32_swap_b32 v4, v5
  v_add_f32 v4, v4, v5
  v_fmaak_f32 v8, v4, v9, 0xc0600000
  s_waitcnt lgkmcnt(7)
  v_mfma_f32_32x32x16_bf16 v[192:207], v[96:99], v[160:163], 0
  ds_read_b128 v[128:131], v16 offset:8192
  s_waitcnt lgkmcnt(7)
  v_mfma_f32_32x32x16_bf16 v[192:207], v[100:103], v[164:167], v[192:207]
  ds_read_b128 v[132:135], v17 offset:8192
  s_waitcnt lgkmcnt(7)
  v_mfma_f32_32x32x16_bf16 v[192:207], v[104:107], v[168:171], v[192:207]
  ds_read_b128 v[136:139], v18 offset:8192
  s_waitcnt lgkmcnt(7)
  v_mfma_f32_32x32x16_bf16 v[192:207], v[108:111], v[172:175], v[192:207]
  ds_read_b128 v[140:143], v19 offset:8192
  s_waitcnt lgkmcnt(7)
  v_mfma_f32_32x32x16_bf16 v[192:207], v[112:115], v[176:179], v[192:207]
  ds_read_b128 v[144:147], v20 offset:8192
  s_waitcnt lgkmcnt(7)
  v_mfma_f32_32x32x16_bf16 v[192:207], v[116:119], v[180:183], v[192:207]
  ds_read_b128 v[148:151], v21 offset:8192
  s_waitcnt lgkmcnt(7)
  v_mfma_f32_32x32x16_bf16 v[192:207], v[120:123], v[184:187], v[192:207]
  ds_read_b128 v[152:155], v22 offset:8192
  s_waitcnt lgkmcnt(7)
  v_mfma_f32_32x32x16_bf16 v[192:207], v[124:127], v[188:191], v[192:207]
  ds_read_b128 v[156:159], v23 offset:8192
  s_waitcnt lgkmcnt(7)
  v_mfma_f32_32x32x16_bf16 v[208:223], v[128:131], v[160:163], 0
  ds_read_b128 v[96:99], v16 offset:16384
  s_waitcnt lgkmcnt(7)
  v_mfma_f32_32x32x16_bf16 v[208:223], v[132:135], v[164:167], v[208:223]
  ds_read_b128 v[100:103], v17 offset:16384
  s_nop 4
  v_fma_f32 v192, v192, s50, v8
  v_fma_f32 v193, v193, s50, v8
  v_exp_f32 v192, v192
  v_fma_f32 v194, v194, s50, v8
  s_waitcnt lgkmcnt(7)
  v_mfma_f32_32x32x16_bf16 v[208:223], v[136:139], v[168:171], v[208:223]
  ds_read_b128 v[104:107], v18 offset:16384
  v_exp_f32 v193, v193
  v_fma_f32 v195, v195, s50, v8
  v_exp_f32 v194, v194
  v_cvt_pk_bf16_f32 v32, v192, v193
  s_waitcnt lgkmcnt(7)
  v_mfma_f32_32x32x16_bf16 v[208:223], v[140:143], v[172:175], v[208:223]
  ds_read_b128 v[108:111], v19 offset:16384
  v_fma_f32 v196, v196, s50, v8
  v_exp_f32 v195, v195
  v_fma_f32 v197, v197, s50, v8
  v_exp_f32 v196, v196
  s_waitcnt lgkmcnt(7)
  v_mfma_f32_32x32x16_bf16 v[208:223], v[144:147], v[176:179], v[208:223]
  ds_read_b128 v[112:115], v20 offset:16384
  v_cvt_pk_bf16_f32 v33, v194, v195
  v_fma_f32 v198, v198, s50, v8
  v_exp_f32 v197, v197
  v_fma_f32 v199, v199, s50, v8
  s_waitcnt lgkmcnt(7)
  v_mfma_f32_32x32x16_bf16 v[208:223], v[148:151], v[180:183], v[208:223]
  ds_read_b128 v[116:119], v21 offset:16384
  v_exp_f32 v198, v198
  v_cvt_pk_bf16_f32 v34, v196, v197
  v_fma_f32 v200, v200, s50, v8
  v_exp_f32 v199, v199
  s_waitcnt lgkmcnt(7)
  v_mfma_f32_32x32x16_bf16 v[208:223], v[152:155], v[184:187], v[208:223]
  ds_read_b128 v[120:123], v22 offset:16384
  v_fma_f32 v201, v201, s50, v8
  v_exp_f32 v200, v200
  v_cvt_pk_bf16_f32 v35, v198, v199
  v_fma_f32 v202, v202, s50, v8
  s_waitcnt lgkmcnt(7)
  v_mfma_f32_32x32x16_bf16 v[208:223], v[156:159], v[188:191], v[208:223]
  ds_read_b128 v[124:127], v23 offset:16384
  v_exp_f32 v201, v201
  v_fma_f32 v203, v203, s50, v8
  v_exp_f32 v202, v202
  v_cvt_pk_bf16_f32 v36, v200, v201
  v_fma_f32 v204, v204, s50, v8
  v_exp_f32 v203, v203
  v_fma_f32 v205, v205, s50, v8
  v_exp_f32 v204, v204
  v_cvt_pk_bf16_f32 v37, v202, v203
  v_fma_f32 v206, v206, s50, v8
  v_exp_f32 v205, v205
  v_fma_f32 v207, v207, s50, v8
  v_exp_f32 v206, v206
  v_cvt_pk_bf16_f32 v38, v204, v205
  v_exp_f32 v207, v207
  s_nop 0
  v_cvt_pk_bf16_f32 v39, v206, v207
  s_waitcnt lgkmcnt(7)
  v_mfma_f32_32x32x16_bf16 v[192:207], v[96:99], v[160:163], 0
  ds_read_b128 v[128:131], v16 offset:24576
  s_waitcnt lgkmcnt(7)
  v_mfma_f32_32x32x16_bf16 v[192:207], v[100:103], v[164:167], v[192:207]
  ds_read_b128 v[132:135], v17 offset:24576
  v_fma_f32 v208, v208, s50, v8
  v_fma_f32 v209, v209, s50, v8
  v_exp_f32 v208, v208
  v_fma_f32 v210, v210, s50, v8
  s_waitcnt lgkmcnt(7)
  v_mfma_f32_32x32x16_bf16 v[192:207], v[104:107], v[168:171], v[192:207]
  ds_read_b128 v[136:139], v18 offset:24576
  v_exp_f32 v209, v209
  v_fma_f32 v211, v211, s50, v8
  v_exp_f32 v210, v210
  v_cvt_pk_bf16_f32 v40, v208, v209
  s_waitcnt lgkmcnt(7)
  v_mfma_f32_32x32x16_bf16 v[192:207], v[108:111], v[172:175], v[192:207]
  ds_read_b128 v[140:143], v19 offset:24576
  v_fma_f32 v212, v212, s50, v8
  v_exp_f32 v211, v211
  v_fma_f32 v213, v213, s50, v8
  v_exp_f32 v212, v212
  s_waitcnt lgkmcnt(7)
  v_mfma_f32_32x32x16_bf16 v[192:207], v[112:115], v[176:179], v[192:207]
  ds_read_b128 v[144:147], v20 offset:24576
  v_cvt_pk_bf16_f32 v41, v210, v211
  v_fma_f32 v214, v214, s50, v8
  v_exp_f32 v213, v213
  v_fma_f32 v215, v215, s50, v8
  s_waitcnt lgkmcnt(7)
  v_mfma_f32_32x32x16_bf16 v[192:207], v[116:119], v[180:183], v[192:207]
  ds_read_b128 v[148:151], v21 offset:24576
  v_exp_f32 v214, v214
  v_cvt_pk_bf16_f32 v42, v212, v213
  v_fma_f32 v216, v216, s50, v8
  v_exp_f32 v215, v215
  s_waitcnt lgkmcnt(7)
  v_mfma_f32_32x32x16_bf16 v[192:207], v[120:123], v[184:187], v[192:207]
  ds_read_b128 v[152:155], v22 offset:24576
  v_fma_f32 v217, v217, s50, v8
  v_exp_f32 v216, v216
  v_cvt_pk_bf16_f32 v43, v214, v215
  v_fma_f32 v218, v218, s50, v8
  s_waitcnt lgkmcnt(7)
  v_mfma_f32_32x32x16_bf16 v[192:207], v[124:127], v[188:191], v[192:207]
  ds_read_b128 v[156:159], v23 offset:24576
  v_exp_f32 v217, v217
  v_fma_f32 v219, v219, s50, v8
  v_exp_f32 v218, v218
  v_cvt_pk_bf16_f32 v44, v216, v217
  v_fma_f32 v220, v220, s50, v8
  v_exp_f32 v219, v219
  v_fma_f32 v221, v221, s50, v8
  v_exp_f32 v220, v220
  v_cvt_pk_bf16_f32 v45, v218, v219
  v_fma_f32 v222, v222, s50, v8
  v_exp_f32 v221, v221
  v_fma_f32 v223, v223, s50, v8
  v_exp_f32 v222, v222
  v_cvt_pk_bf16_f32 v46, v220, v221
  v_exp_f32 v223, v223
  s_nop 0
  v_cvt_pk_bf16_f32 v47, v222, v223
  s_waitcnt lgkmcnt(7)
  v_mfma_f32_32x32x16_bf16 v[208:223], v[128:131], v[160:163], 0
  s_waitcnt lgkmcnt(6)
  v_mfma_f32_32x32x16_bf16 v[208:223], v[132:135], v[164:167], v[208:223]
  v_fma_f32 v192, v192, s50, v8
  v_fma_f32 v193, v193, s50, v8
  v_exp_f32 v192, v192
  v_fma_f32 v194, v194, s50, v8
  v_exp_f32 v193, v193
  s_waitcnt lgkmcnt(5)
  v_mfma_f32_32x32x16_bf16 v[208:223], v[136:139], v[168:171], v[208:223]
  v_fma_f32 v195, v195, s50, v8
  v_exp_f32 v194, v194
  v_cvt_pk_bf16_f32 v48, v192, v193
  v_fma_f32 v196, v196, s50, v8
  v_exp_f32 v195, v195
  s_waitcnt lgkmcnt(4)
  v_mfma_f32_32x32x16_bf16 v[208:223], v[140:143], v[172:175], v[208:223]
  v_fma_f32 v197, v197, s50, v8
  v_exp_f32 v196, v196
  v_cvt_pk_bf16_f32 v49, v194, v195
  v_fma_f32 v198, v198, s50, v8
  v_exp_f32 v197, v197
  s_waitcnt lgkmcnt(3)
  v_mfma_f32_32x32x16_bf16 v[208:223], v[144:147], v[176:179], v[208:223]
  v_fma_f32 v199, v199, s50, v8
  v_exp_f32 v198, v198
  v_cvt_pk_bf16_f32 v50, v196, v197
  v_fma_f32 v200, v200, s50, v8
  v_exp_f32 v199, v199
  s_waitcnt lgkmcnt(2)
  v_mfma_f32_32x32x16_bf16 v[208:223], v[148:151], v[180:183], v[208:223]
  v_fma_f32 v201, v201, s50, v8
  v_exp_f32 v200, v200
  v_cvt_pk_bf16_f32 v51, v198, v199
  v_fma_f32 v202, v202, s50, v8
  v_exp_f32 v201, v201
  s_waitcnt lgkmcnt(1)
  v_mfma_f32_32x32x16_bf16 v[208:223], v[152:155], v[184:187], v[208:223]
  v_fma_f32 v203, v203, s50, v8
  v_exp_f32 v202, v202
  v_cvt_pk_bf16_f32 v52, v200, v201
  v_fma_f32 v204, v204, s50, v8
  v_exp_f32 v203, v203
  s_waitcnt lgkmcnt(0)
  v_mfma_f32_32x32x16_bf16 v[208:223], v[156:159], v[188:191], v[208:223]
  v_fma_f32 v205, v205, s50, v8
  v_exp_f32 v204, v204
  v_cvt_pk_bf16_f32 v53, v202, v203
  v_fma_f32 v206, v206, s50, v8
  v_exp_f32 v205, v205
  v_fma_f32 v207, v207, s50, v8
  v_exp_f32 v206, v206
  v_cvt_pk_bf16_f32 v54, v204, v205
  v_exp_f32 v207, v207
  s_nop 0
  v_cvt_pk_bf16_f32 v55, v206, v207
  s_nop 0
  v_fma_f32 v208, v208, s50, v8
  v_fma_f32 v209, v209, s50, v8
  v_exp_f32 v208, v208
  v_fma_f32 v210, v210, s50, v8
  v_exp_f32 v209, v209
  v_fma_f32 v211, v211, s50, v8
  v_exp_f32 v210, v210
  v_cvt_pk_bf16_f32 v56, v208, v209
  v_fma_f32 v212, v212, s50, v8
  v_exp_f32 v211, v211
  v_fma_f32 v213, v213, s50, v8
  v_exp_f32 v212, v212
  v_cvt_pk_bf16_f32 v57, v210, v211
  v_fma_f32 v214, v214, s50, v8
  v_exp_f32 v213, v213
  v_fma_f32 v215, v215, s50, v8
  v_exp_f32 v214, v214
  v_cvt_pk_bf16_f32 v58, v212, v213
  v_fma_f32 v216, v216, s50, v8
  v_exp_f32 v215, v215
  v_fma_f32 v217, v217, s50, v8
  v_exp_f32 v216, v216
  v_cvt_pk_bf16_f32 v59, v214, v215
  v_fma_f32 v218, v218, s50, v8
  v_exp_f32 v217, v217
  v_fma_f32 v219, v219, s50, v8
  v_exp_f32 v218, v218
  v_cvt_pk_bf16_f32 v60, v216, v217
  v_fma_f32 v220, v220, s50, v8
  v_exp_f32 v219, v219
  v_fma_f32 v221, v221, s50, v8
  v_exp_f32 v220, v220
  v_cvt_pk_bf16_f32 v61, v218, v219
  v_fma_f32 v222, v222, s50, v8
  v_exp_f32 v221, v221
  v_fma_f32 v223, v223, s50, v8
  v_exp_f32 v222, v222
  v_cvt_pk_bf16_f32 v62, v220, v221
  v_exp_f32 v223, v223
  s_nop 0
  v_cvt_pk_bf16_f32 v63, v222, v223
  v_lshrrev_b32 v3, 5, v2
  v_lshlrev_b32 v10, 4, v3
  v_add_u32 v10, 155904, v10
  v_and_b32 v4, 31, v2
  v_and_b32 v5, 7, v2
  v_and_b32 v8, 1, v2
  v_lshl_add_u32 v5, v8, 3, v5
  v_lshlrev_b32 v5, 4, v5
  v_lshl_add_u32 v5, v4, 8, v5
  v_lshl_add_u32 v5, v3, 3, v5
  s_lshl_b32 s62, s3, 13
  s_add_u32 s57, s62, 32768
  v_add_u32 v240, s57, v5
  v_xor_b32 v241, 16, v240
  v_xor_b32 v242, 32, v240
  v_xor_b32 v243, 48, v240
  v_xor_b32 v244, 64, v240
  v_xor_b32 v245, 80, v240
  v_xor_b32 v246, 96, v240
  v_xor_b32 v247, 112, v240
  v_lshrrev_b32 v3, 3, v2
  v_and_b32 v4, 7, v2
  v_xor_b32 v5, v4, v3
  v_and_b32 v8, 1, v3
  v_lshl_add_u32 v5, v8, 3, v5
  v_lshlrev_b32 v5, 4, v5
  v_lshl_add_u32 v5, v3, 8, v5
  v_add_u32 v12, s57, v5
  v_xor_b32 v13, 128, v12
  v_lshlrev_b32 v4, 4, v4
  v_lshl_add_u32 v14, v3, 8, v4
  s_add_u32 s62, s62, s19
  s_and_b32 s62, s62, 0xffff
  s_add_u32 s62, s62, s18
  s_add_u32 s61, s62, 4096
  s_barrier
  ds_read_b128 v[64:67], v10 offset:0
  ds_read_b128 v[68:71], v10 offset:32
  ds_read_b128 v[72:75], v10 offset:64
  ds_read_b128 v[76:79], v10 offset:96
  ds_read_b128 v[80:83], v10 offset:128
  ds_read_b128 v[84:87], v10 offset:160
  ds_read_b128 v[88:91], v10 offset:192
  ds_read_b128 v[92:95], v10 offset:224
  s_waitcnt lgkmcnt(0)
  v_dot2_f32_bf16 v4, v32, v64, 0
  v_dot2_f32_bf16 v5, v33, v65, 0
  v_dot2_f32_bf16 v4, v34, v66, v4
  v_dot2_f32_bf16 v5, v35, v67, v5
  v_dot2_f32_bf16 v4, v36, v68, v4
  v_dot2_f32_bf16 v5, v37, v69, v5
  v_dot2_f32_bf16 v4, v38, v70, v4
  v_dot2_f32_bf16 v5, v39, v71, v5
  v_dot2_f32_bf16 v4, v40, v72, v4
  v_dot2_f32_bf16 v5, v41, v73, v5
  v_dot2_f32_bf16 v4, v42, v74, v4
  v_dot2_f32_bf16 v5, v43, v75, v5
  v_dot2_f32_bf16 v4, v44, v76, v4
  v_dot2_f32_bf16 v5, v45, v77, v5
  v_dot2_f32_bf16 v4, v46, v78, v4
  v_dot2_f32_bf16 v5, v47, v79, v5
  v_dot2_f32_bf16 v4, v48, v80, v4
  v_dot2_f32_bf16 v5, v49, v81, v5
  v_dot2_f32_bf16 v4, v50, v82, v4
  v_dot2_f32_bf16 v5, v51, v83, v5
  v_dot2_f32_bf16 v4, v52, v84, v4
  v_dot2_f32_bf16 v5, v53, v85, v5
  v_dot2_f32_bf16 v4, v54, v86, v4
  v_dot2_f32_bf16 v5, v55, v87, v5
  v_dot2_f32_bf16 v4, v56, v88, v4
  v_dot2_f32_bf16 v5, v57, v89, v5
  v_dot2_f32_bf16 v4, v58, v90, v4
  v_dot2_f32_bf16 v5, v59, v91, v5
  v_dot2_f32_bf16 v4, v60, v92, v4
  v_dot2_f32_bf16 v5, v61, v93, v5
  v_dot2_f32_bf16 v4, v62, v94, v4
  v_dot2_f32_bf16 v5, v63, v95, v5
  s_nop 2
  v_add_f32 v4, v4, v5
  v_mov_b32 v5, v4
  s_nop 1
  v_permlane32_swap_b32 v4, v5
  v_add_f32 v4, v4, v5
  v_add_f32 v4, 0x358637bd, v4
  v_rcp_f32 v8, v4
  s_barrier
  ds_read_b128 v[96:99], v28 offset:0
  ds_read_b128 v[100:103], v28 offset:1024
  ds_read_b128 v[104:107], v28 offset:2048
  ds_read_b128 v[108:111], v28 offset:3072
  ds_read_b128 v[112:115], v28 offset:4096
  ds_read_b128 v[116:119], v28 offset:5120
  ds_read_b128 v[120:123], v28 offset:6144
  ds_read_b128 v[124:127], v28 offset:7168
  s_branch L_out
L_kw:
  s_setprio 1
  v_mov_b32 v9, 0xbd8293ee
  s_mov_b32 s50, 0x3edb9ada
  s_mov_b32 s60, 0
  s_mov_b32 s69, 100000
  v_and_b32 v3, 31, v2
  v_lshrrev_b32 v4, 5, v2
  v_and_b32 v5, 15, v2
  v_xor_b32 v5, v5, v4
  v_lshlrev_b32 v5, 4, v5
  v_lshl_add_u32 v16, v3, 8, v5
  v_xor_b32 v17, 32, v16
  v_xor_b32 v18, 64, v16
  v_xor_b32 v19, 96, v16
  v_xor_b32 v20, 128, v16
  v_xor_b32 v21, 160, v16
  v_xor_b32 v22, 192, v16
  v_xor_b32 v23, 224, v16
  v_lshlrev_b32 v28, 4, v2
  v_mov_b32 v29, 155648
  v_and_b32 v11, 7, v2
  v_lshlrev_b32 v11, 2, v11
  s_lshl_b32 s57, s54, 7
  s_add_u32 s63, s67, 299008
  s_add_u32 s63, s63, s57
  s_lshl_b32 s57, s54, 10
  s_add_u32 s52, s67, 294912
  s_add_u32 s52, s52, s57
  s_lshl_b32 s58, s54, 13
  s_add_u32 s51, s67, 262144
  s_add_u32 s51, s51, s58
  s_add_u32 s57, s67, s58
  s_lshl_b32 s58, s49, 10
  s_add_u32 s98, s57, s58
  s_add_u32 s100, s51, s58
  s_lshl_b32 s58, s49, 15
  s_add_u32 s99, s57, s58
  s_getreg_b32 s64, hwreg(HW_REG_XCC_ID, 0, 3)
  s_lshl_b32 s64, s64, 2
  s_lshl_b32 s65, s48, 3
  s_lshl_b32 s57, s49, 2
  s_add_u32 s53, s52, s57
  s_add_u32 s59, s63, s57
  s_add_u32 s16, s36, s63
  s_addc_u32 s17, s37, 0
  s_cmp_lg_u32 s3, 0
  s_cbranch_scc1 L_nohs
  v_and_b32 v3, 3, v2
  v_lshlrev_b32 v3, 7, v3
  v_bfe_u32 v4, v2, 2, 1
  v_lshl_add_u32 v3, v4, 6, v3
  v_bfe_u32 v4, v2, 3, 1
  v_lshl_add_u32 v3, v4, 9, v3
  v_mov_b32 v4, 0
  s_mov_b64 exec, 0x1ff
  buffer_store_dword v4, v3, s[36:39], s59 offen sc1
  s_mov_b64 exec, -1
L_nohs:
  s_lshl_b32 s57, s3, 2
  s_add_u32 s58, s57, 155680
  v_mov_b32 v31, s58
  v_bfe_u32 v3, v2, 2, 2
  v_lshrrev_b32 v1, 5, v2
  v_lshlrev_b32 v30, 4, v1
  v_add_u32 v30, 156672, v30
  v_lshl_add_u32 v1, v1, 2, v3
  v_lshlrev_b32 v1, 8, v1
  v_bfe_u32 v8, v2, 4, 1
  v_lshl_add_u32 v1, v8, 5, v1
  v_and_b32 v8, 3, v2
  v_lshl_add_u32 v1, v8, 3, v1
  v_lshl_add_u32 v1, v3, 6, v1
  v_add_u32 v24, 32768, v1
  s_add_u32 s68, s3, 7
  s_mov_b32 s6, 0xffff0000
  s_lshl_b32 s62, s3, 13
  v_xor_b32 v25, 64, v24
  v_xor_b32 v26, 128, v24
  v_xor_b32 v27, 192, v24
  v_add_u32 v240, s62, v16
  v_add_u32 v241, s62, v17
  v_add_u32 v242, s62, v18
  v_add_u32 v243, s62, v19
  v_add_u32 v244, s62, v20
  v_add_u32 v245, s62, v21
  v_add_u32 v246, s62, v22
  v_add_u32 v247, s62, v23
  v_add_u32 v16, 98304, v16
  v_add_u32 v17, 98304, v17
  v_add_u32 v18, 98304, v18
  v_add_u32 v19, 98304, v19
  v_add_u32 v20, 98304, v20
  v_add_u32 v21, 98304, v21
  v_add_u32 v22, 98304, v22
  v_add_u32 v23, 98304, v23
  v_mov_b64 v[96:97], 0
  v_mov_b64 v[98:99], 0
  v_mov_b64 v[100:101], 0
  v_mov_b64 v[102:103], 0
  v_mov_b64 v[104:105], 0
  v_mov_b64 v[106:107], 0
  v_mov_b64 v[108:109], 0
  v_mov_b64 v[110:111], 0
  v_mov_b64 v[112:113], 0
  v_mov_b64 v[114:115], 0
  v_mov_b64 v[116:117], 0
  v_mov_b64 v[118:119], 0
  v_mov_b64 v[120:121], 0
  v_mov_b64 v[122:123], 0
  v_mov_b64 v[124:125], 0
  v_mov_b64 v[126:127], 0
  v_mov_b64 v[128:129], 0
  v_mov_b64 v[130:131], 0
  v_mov_b64 v[132:133], 0
  v_mov_b64 v[134:135], 0
  v_mov_b64 v[136:137], 0
  v_mov_b64 v[138:139], 0
  v_mov_b64 v[140:141], 0
  v_mov_b64 v[142:143], 0
  v_mov_b64 v[144:145], 0
  v_mov_b64 v[146:147], 0
  v_mov_b64 v[148:149], 0
  v_mov_b64 v[150:151], 0
  v_mov_b64 v[152:153], 0
  v_mov_b64 v[154:155], 0
  v_mov_b64 v[156:157], 0
  v_mov_b64 v[158:159], 0
L_pp15:
  s_nop 0
  ds_read_b128 v[250:253], v29 offset:0
  s_sub_u32 s69, s69, 1
  s_cbranch_scc1 L_ppd16
  s_waitcnt lgkmcnt(0)
  v_min_u32 v250, v250, v251
  v_min3_u32 v250, v250, v252, v253
  s_nop 0
  v_readfirstlane_b32 s60, v250
  s_nop 0
  s_cmp_lt_u32 s60, 4
  s_cbranch_scc1 L_pp15
L_ppd16:
  ds_read_b128 v[64:67], v240 offset:0
  ds_read_b128 v[68:71], v241 offset:0
  ds_read_b128 v[72:75], v242 offset:0
  ds_read_b128 v[76:79], v243 offset:0
  ds_read_b128 v[80:83], v244 offset:0
  ds_read_b128 v[84:87], v245 offset:0
  ds_read_b128 v[88:91], v246 offset:0
  ds_read_b128 v[92:95], v247 offset:0
  s_waitcnt lgkmcnt(7)
  v_lshlrev_b32 v224, 16, v64
  v_and_b32 v225, s6, v64
  v_mul_f32 v224, s50, v224
  v_mul_f32 v225, s50, v225
  v_cvt_pk_bf16_f32 v64, v224, v225
  v_lshlrev_b32 v226, 16, v65
  v_and_b32 v227, s6, v65
  v_mul_f32 v226, s50, v226
  v_mul_f32 v227, s50, v227
  v_cvt_pk_bf16_f32 v65, v226, v227
  v_lshlrev_b32 v224, 16, v66
  v_and_b32 v225, s6, v66
  v_mul_f32 v224, s50, v224
  v_mul_f32 v225, s50, v225
  v_cvt_pk_bf16_f32 v66, v224, v225
  v_lshlrev_b32 v226, 16, v67
  v_and_b32 v227, s6, v67
  v_mul_f32 v226, s50, v226
  v_mul_f32 v227, s50, v227
  v_cvt_pk_bf16_f32 v67, v226, v227
  s_waitcnt lgkmcnt(6)
  v_lshlrev_b32 v224, 16, v68
  v_and_b32 v225, s6, v68
  v_mul_f32 v224, s50, v224
  v_mul_f32 v225, s50, v225
  v_cvt_pk_bf16_f32 v68, v224, v225
  v_lshlrev_b32 v226, 16, v69
  v_and_b32 v227, s6, v69
  v_mul_f32 v226, s50, v226
  v_mul_f32 v227, s50, v227
  v_cvt_pk_bf16_f32 v69, v226, v227
  v_lshlrev_b32 v224, 16, v70
  v_and_b32 v225, s6, v70
  v_mul_f32 v224, s50, v224
  v_mul_f32 v225, s50, v225
  v_cvt_pk_bf16_f32 v70, v224, v225
  v_lshlrev_b32 v226, 16, v71
  v_and_b32 v227, s6, v71
  v_mul_f32 v226, s50, v226
  v_mul_f32 v227, s50, v227
  v_cvt_pk_bf16_f32 v71, v226, v227
  s_waitcnt lgkmcnt(5)
  v_lshlrev_b32 v224, 16, v72
  v_and_b32 v225, s6, v72
  v_mul_f32 v224, s50, v224
  v_mul_f32 v225, s50, v225
  v_cvt_pk_bf16_f32 v72, v224, v225
  v_lshlrev_b32 v226, 16, v73
  v_and_b32 v227, s6, v73
  v_mul_f32 v226, s50, v226
  v_mul_f32 v227, s50, v227
  v_cvt_pk_bf16_f32 v73, v226, v227
  v_lshlrev_b32 v224, 16, v74
  v_and_b32 v225, s6, v74
  v_mul_f32 v224, s50, v224
  v_mul_f32 v225, s50, v225
  v_cvt_pk_bf16_f32 v74, v224, v225
  v_lshlrev_b32 v226, 16, v75
  v_and_b32 v227, s6, v75
  v_mul_f32 v226, s50, v226
  v_mul_f32 v227, s50, v227
  v_cvt_pk_bf16_f32 v75, v226, v227
  s_waitcnt lgkmcnt(4)
  v_lshlrev_b32 v224, 16, v76
  v_and_b32 v225, s6, v76
  v_mul_f32 v224, s50, v224
  v_mul_f32 v225, s50, v225
  v_cvt_pk_bf16_f32 v76, v224, v225
  v_lshlrev_b32 v226, 16, v77
  v_and_b32 v227, s6, v77
  v_mul_f32 v226, s50, v226
  v_mul_f32 v227, s50, v227
  v_cvt_pk_bf16_f32 v77, v226, v227
  v_lshlrev_b32 v224, 16, v78
  v_and_b32 v225, s6, v78
  v_mul_f32 v224, s50, v224
  v_mul_f32 v225, s50, v225
  v_cvt_pk_bf16_f32 v78, v224, v225
  v_lshlrev_b32 v226, 16, v79
  v_and_b32 v227, s6, v79
  v_mul_f32 v226, s50, v226
  v_mul_f32 v227, s50, v227
  v_cvt_pk_bf16_f32 v79, v226, v227
  s_waitcnt lgkmcnt(3)
  v_lshlrev_b32 v224, 16, v80
  v_and_b32 v225, s6, v80
  v_mul_f32 v224, s50, v224
  v_mul_f32 v225, s50, v225
  v_cvt_pk_bf16_f32 v80, v224, v225
  v_lshlrev_b32 v226, 16, v81
  v_and_b32 v227, s6, v81
  v_mul_f32 v226, s50, v226
  v_mul_f32 v227, s50, v227
  v_cvt_pk_bf16_f32 v81, v226, v227
  v_lshlrev_b32 v224, 16, v82
  v_and_b32 v225, s6, v82
  v_mul_f32 v224, s50, v224
  v_mul_f32 v225, s50, v225
  v_cvt_pk_bf16_f32 v82, v224, v225
  v_lshlrev_b32 v226, 16, v83
  v_and_b32 v227, s6, v83
  v_mul_f32 v226, s50, v226
  v_mul_f32 v227, s50, v227
  v_cvt_pk_bf16_f32 v83, v226, v227
  s_waitcnt lgkmcnt(2)
  v_lshlrev_b32 v224, 16, v84
  v_and_b32 v225, s6, v84
  v_mul_f32 v224, s50, v224
  v_mul_f32 v225, s50, v225
  v_cvt_pk_bf16_f32 v84, v224, v225
  v_lshlrev_b32 v226, 16, v85
  v_and_b32 v227, s6, v85
  v_mul_f32 v226, s50, v226
  v_mul_f32 v227, s50, v227
  v_cvt_pk_bf16_f32 v85, v226, v227
  v_lshlrev_b32 v224, 16, v86
  v_and_b32 v225, s6, v86
  v_mul_f32 v224, s50, v224
  v_mul_f32 v225, s50, v225
  v_cvt_pk_bf16_f32 v86, v224, v225
  v_lshlrev_b32 v226, 16, v87
  v_and_b32 v227, s6, v87
  v_mul_f32 v226, s50, v226
  v_mul_f32 v227, s50, v227
  v_cvt_pk_bf16_f32 v87, v226, v227
  s_waitcnt lgkmcnt(1)
  v_lshlrev_b32 v224, 16, v88
  v_and_b32 v225, s6, v88
  v_mul_f32 v224, s50, v224
  v_mul_f32 v225, s50, v225
  v_cvt_pk_bf16_f32 v88, v224, v225
  v_lshlrev_b32 v226, 16, v89
  v_and_b32 v227, s6, v89
  v_mul_f32 v226, s50, v226
  v_mul_f32 v227, s50, v227
  v_cvt_pk_bf16_f32 v89, v226, v227
  v_lshlrev_b32 v224, 16, v90
  v_and_b32 v225, s6, v90
  v_mul_f32 v224, s50, v224
  v_mul_f32 v225, s50, v225
  v_cvt_pk_bf16_f32 v90, v224, v225
  v_lshlrev_b32 v226, 16, v91
  v_and_b32 v227, s6, v91
  v_mul_f32 v226, s50, v226
  v_mul_f32 v227, s50, v227
  v_cvt_pk_bf16_f32 v91, v226, v227
  s_waitcnt lgkmcnt(0)
  v_lshlrev_b32 v224, 16, v92
  v_and_b32 v225, s6, v92
  v_mul_f32 v224, s50, v224
  v_mul_f32 v225, s50, v225
  v_cvt_pk_bf16_f32 v92, v224, v225
  v_lshlrev_b32 v226, 16, v93
  v_and_b32 v227, s6, v93
  v_mul_f32 v226, s50, v226
  v_mul_f32 v227, s50, v227
  v_cvt_pk_bf16_f32 v93, v226, v227
  v_lshlrev_b32 v224, 16, v94
  v_and_b32 v225, s6, v94
  v_mul_f32 v224, s50, v224
  v_mul_f32 v225, s50, v225
  v_cvt_pk_bf16_f32 v94, v224, v225
  v_lshlrev_b32 v226, 16, v95
  v_and_b32 v227, s6, v95
  v_mul_f32 v226, s50, v226
  v_mul_f32 v227, s50, v227
  v_cvt_pk_bf16_f32 v95, v226, v227
  s_cmp_lg_u32 s3, 0
  s_cbranch_scc1 L_nohs2
  s_lshl_b32 s58, 1, s64
  v_mov_b32 v10, s58
  s_mov_b64 exec, 1
  s_waitcnt vmcnt(0)
  buffer_atomic_add v10, off, s[44:47], s65 sc0 sc1
  s_mov_b64 exec, -1
L_nohs2:
  s_lshl_b32 s57, s49, 2
  s_add_u32 s65, s67, 299520
  s_add_u32 s66, s65, s57
  v_mov_b32 v8, 0
  v_mov_b32 v9, 0
  s_cmp_lt_u32 s60, 5
  s_cbranch_scc1 L_pp17
L_ppd18:
  ds_read_b128 v[192:195], v30 offset:0
  ds_read_b128 v[196:199], v30 offset:32
  ds_read_b128 v[200:203], v30 offset:64
  ds_read_b128 v[204:207], v30 offset:96
  ds_read_b128 v[160:163], v16 offset:0
  ds_read_b128 v[164:167], v17 offset:0
  ds_read_b128 v[168:171], v18 offset:0
  ds_read_b128 v[172:175], v19 offset:0
  ds_read_b128 v[176:179], v20 offset:0
  ds_read_b128 v[180:183], v21 offset:0
  ds_read_b128 v[184:187], v22 offset:0
  ds_read_b128 v[188:191], v23 offset:0
  s_waitcnt lgkmcnt(7)
  v_mfma_f32_32x32x16_bf16 v[192:207], v[160:163], v[64:67], v[192:207]
  ds_read_b128 v[4:7], v29
  s_waitcnt lgkmcnt(7)
  v_mfma_f32_32x32x16_bf16 v[192:207], v[164:167], v[68:71], v[192:207]
  s_waitcnt lgkmcnt(6)
  v_mfma_f32_32x32x16_bf16 v[192:207], v[168:171], v[72:75], v[192:207]
  s_waitcnt lgkmcnt(0)
  v_min_u32 v4, v4, v5
  v_min3_u32 v4, v4, v6, v7
  s_nop 0
  v_readfirstlane_b32 s60, v4
  v_mfma_f32_32x32x16_bf16 v[192:207], v[172:175], v[76:79], v[192:207]
  s_cmp_lt_u32 s60, 6
  s_cbranch_scc1 L_pp19
L_ppd20:
  ds_read_b128 v[32:35], v16 offset:8192
  ds_read_b128 v[36:39], v17 offset:8192
  v_mfma_f32_32x32x16_bf16 v[192:207], v[176:179], v[80:83], v[192:207]
  ds_read_b128 v[40:43], v18 offset:8192
  ds_read_b128 v[44:47], v19 offset:8192
  v_mfma_f32_32x32x16_bf16 v[192:207], v[180:183], v[84:87], v[192:207]
  ds_read_b128 v[48:51], v20 offset:8192
  ds_read_b128 v[52:55], v21 offset:8192
  v_mfma_f32_32x32x16_bf16 v[192:207], v[184:187], v[88:91], v[192:207]
  ds_read_b128 v[56:59], v22 offset:8192
  ds_read_b128 v[60:63], v23 offset:8192
  ds_read_b128 v[208:211], v30 offset:128
  ds_read_b128 v[212:215], v30 offset:160
  ds_read_b128 v[216:219], v30 offset:192
  ds_read_b128 v[220:223], v30 offset:224
  v_mfma_f32_32x32x16_bf16 v[192:207], v[188:191], v[92:95], v[192:207]
  v_mov_b32 v1, 1
  s_mov_b64 exec, 1
  ds_write_b32 v31, v1 offset:0
  s_mov_b64 exec, -1
  s_waitcnt lgkmcnt(1)
  v_mfma_f32_32x32x16_bf16 v[208:223], v[32:35], v[64:67], v[208:223]
  ds_read_b128 v[4:7], v29
  v_mfma_f32_32x32x16_bf16 v[208:223], v[36:39], v[68:71], v[208:223]
  s_nop 3
  v_exp_f32 v192, v192
  v_exp_f32 v193, v193
  v_add_f32 v8, v8, v192
  v_mfma_f32_32x32x16_bf16 v[208:223], v[40:43], v[72:75], v[208:223]
  s_waitcnt lgkmcnt(0)
  v_min_u32 v4, v4, v5
  v_min3_u32 v4, v4, v6, v7
  s_nop 0
  v_readfirstlane_b32 s60, v4
  v_exp_f32 v194, v194
  v_add_f32 v9, v9, v193
  v_mfma_f32_32x32x16_bf16 v[208:223], v[44:47], v[76:79], v[208:223]
  s_cmp_lt_u32 s60, 8
  s_cbranch_scc1 L_pp21
L_ppd22:
  ds_read_b128 v[160:163], v16 offset:16384
  ds_read_b128 v[164:167], v17 offset:16384
  v_cvt_pk_bf16_f32 v224, v192, v193
  v_exp_f32 v195, v195
  v_add_f32 v8, v8, v194
  v_mfma_f32_32x32x16_bf16 v[208:223], v[48:51], v[80:83], v[208:223]
  ds_read_b128 v[168:171], v18 offset:16384
  ds_read_b128 v[172:175], v19 offset:16384
  v_exp_f32 v196, v196
  v_add_f32 v9, v9, v195
  v_cvt_pk_bf16_f32 v225, v194, v195
  v_mfma_f32_32x32x16_bf16 v[208:223], v[52:55], v[84:87], v[208:223]
  ds_read_b128 v[176:179], v20 offset:16384
  ds_read_b128 v[180:183], v21 offset:16384
  v_exp_f32 v197, v197
  v_add_f32 v8, v8, v196
  v_mfma_f32_32x32x16_bf16 v[208:223], v[56:59], v[88:91], v[208:223]
  v_exp_f32 v198, v198
  v_add_f32 v9, v9, v197
  v_cvt_pk_bf16_f32 v226, v196, v197
  v_exp_f32 v199, v199
  v_add_f32 v8, v8, v198
  v_exp_f32 v200, v200
  v_add_f32 v9, v9, v199
  v_cvt_pk_bf16_f32 v227, v198, v199
  v_exp_f32 v201, v201
  v_add_f32 v8, v8, v200
  v_exp_f32 v202, v202
  v_add_f32 v9, v9, v201
  v_cvt_pk_bf16_f32 v228, v200, v201
  v_exp_f32 v203, v203
  v_add_f32 v8, v8, v202
  v_exp_f32 v204, v204
  v_add_f32 v9, v9, v203
  v_cvt_pk_bf16_f32 v229, v202, v203
  v_exp_f32 v205, v205
  v_add_f32 v8, v8, v204
  v_exp_f32 v206, v206
  v_add_f32 v9, v9, v205
  v_cvt_pk_bf16_f32 v230, v204, v205
  v_exp_f32 v207, v207
  v_add_f32 v8, v8, v206
  v_add_f32 v9, v9, v207
  v_cvt_pk_bf16_f32 v231, v206, v207
  ds_read_b128 v[184:187], v22 offset:16384
  ds_read_b128 v[188:191], v23 offset:16384
  ds_read_b128 v[192:195], v30 offset:256
  ds_read_b128 v[196:199], v30 offset:288
  ds_read_b128 v[200:203], v30 offset:320
  ds_read_b128 v[204:207], v30 offset:352
  v_mfma_f32_32x32x16_bf16 v[208:223], v[60:63], v[92:95], v[208:223]
  s_waitcnt lgkmcnt(0)
  v_mfma_f32_32x32x16_bf16 v[192:207], v[160:163], v[64:67], v[192:207]
  ds_read_b128 v[4:7], v29
  v_mfma_f32_32x32x16_bf16 v[192:207], v[164:167], v[68:71], v[192:207]
  s_nop 7
  v_exp_f32 v208, v208
  v_exp_f32 v209, v209
  v_add_f32 v8, v8, v208
  v_mfma_f32_32x32x16_bf16 v[192:207], v[168:171], v[72:75], v[192:207]
  s_waitcnt lgkmcnt(0)
  v_min_u32 v4, v4, v5
  v_min3_u32 v4, v4, v6, v7
  s_nop 0
  v_readfirstlane_b32 s60, v4
  v_exp_f32 v210, v210
  v_add_f32 v9, v9, v209
  v_mfma_f32_32x32x16_bf16 v[192:207], v[172:175], v[76:79], v[192:207]
  s_cmp_lt_u32 s60, 9
  s_cbranch_scc1 L_pp23
L_ppd24:
  ds_read_b64_tr_b16 v[32:33], v24 offset:0
  ds_read_b64_tr_b16 v[34:35], v24 offset:2048
  ds_read_b64_tr_b16 v[36:37], v25 offset:0
  ds_read_b64_tr_b16 v[38:39], v25 offset:2048
  v_cvt_pk_bf16_f32 v232, v208, v209
  v_exp_f32 v211, v211
  v_add_f32 v8, v8, v210
  v_mfma_f32_32x32x16_bf16 v[192:207], v[176:179], v[80:83], v[192:207]
  ds_read_b64_tr_b16 v[40:41], v26 offset:0
  ds_read_b64_tr_b16 v[42:43], v26 offset:2048
  ds_read_b64_tr_b16 v[44:45], v27 offset:0
  ds_read_b64_tr_b16 v[46:47], v27 offset:2048
  v_exp_f32 v212, v212
  v_add_f32 v9, v9, v211
  v_cvt_pk_bf16_f32 v233, v210, v211
  v_mfma_f32_32x32x16_bf16 v[192:207], v[180:183], v[84:87], v[192:207]
  ds_read_b64_tr_b16 v[48:49], v24 offset:4096
  ds_read_b64_tr_b16 v[50:51], v24 offset:6144
  ds_read_b64_tr_b16 v[52:53], v25 offset:4096
  ds_read_b64_tr_b16 v[54:55], v25 offset:6144
  v_exp_f32 v213, v213
  v_add_f32 v8, v8, v212
  v_mfma_f32_32x32x16_bf16 v[192:207], v[184:187], v[88:91], v[192:207]
  ds_read_b64_tr_b16 v[56:57], v26 offset:4096
  ds_read_b64_tr_b16 v[58:59], v26 offset:6144
  ds_read_b64_tr_b16 v[60:61], v27 offset:4096
  ds_read_b64_tr_b16 v[62:63], v27 offset:6144
  v_exp_f32 v214, v214
  v_add_f32 v9, v9, v213
  v_cvt_pk_bf16_f32 v234, v212, v213
  v_mfma_f32_32x32x16_bf16 v[192:207], v[188:191], v[92:95], v[192:207]
  v_exp_f32 v215, v215
  v_add_f32 v8, v8, v214
  v_exp_f32 v216, v216
  v_add_f32 v9, v9, v215
  v_mov_b32 v1, 2
  s_mov_b64 exec, 1
  ds_write_b32 v31, v1 offset:0
  s_mov_b64 exec, -1
  s_waitcnt lgkmcnt(15)
  v_mfma_f32_32x32x16_bf16 v[96:111], v[224:227], v[32:35], v[96:111]
  ds_read_b128 v[4:7], v29
  v_cvt_pk_bf16_f32 v235, v214, v215
  v_exp_f32 v217, v217
  v_add_f32 v8, v8, v216
  s_waitcnt lgkmcnt(14)
  v_mfma_f32_32x32x16_bf16 v[112:127], v[224:227], v[36:39], v[112:127]
  v_exp_f32 v218, v218
  v_add_f32 v9, v9, v217
  v_cvt_pk_bf16_f32 v236, v216, v217
  v_exp_f32 v219, v219
  s_waitcnt lgkmcnt(12)
  v_mfma_f32_32x32x16_bf16 v[128:143], v[224:227], v[40:43], v[128:143]
  s_waitcnt lgkmcnt(0)
  v_min_u32 v4, v4, v5
  v_min3_u32 v4, v4, v6, v7
  s_nop 0
  v_readfirstlane_b32 s60, v4
  v_add_f32 v8, v8, v218
  v_exp_f32 v220, v220
  v_mfma_f32_32x32x16_bf16 v[144:159], v[224:227], v[44:47], v[144:159]
  s_cmp_lt_u32 s60, 11
  s_cbranch_scc1 L_pp25
L_ppd26:
  ds_read_b128 v[160:163], v16 offset:24576
  ds_read_b128 v[164:167], v17 offset:24576
  v_add_f32 v9, v9, v219
  v_cvt_pk_bf16_f32 v237, v218, v219
  v_exp_f32 v221, v221
  v_mfma_f32_32x32x16_bf16 v[96:111], v[228:231], v[48:51], v[96:111]
  ds_read_b128 v[168:171], v18 offset:24576
  ds_read_b128 v[172:175], v19 offset:24576
  v_add_f32 v8, v8, v220
  v_exp_f32 v222, v222
  v_add_f32 v9, v9, v221
  v_mfma_f32_32x32x16_bf16 v[112:127], v[228:231], v[52:55], v[112:127]
  ds_read_b128 v[176:179], v20 offset:24576
  ds_read_b128 v[180:183], v21 offset:24576
  v_cvt_pk_bf16_f32 v238, v220, v221
  v_exp_f32 v223, v223
  v_add_f32 v8, v8, v222
  v_mfma_f32_32x32x16_bf16 v[128:143], v[228:231], v[56:59], v[128:143]
  v_add_f32 v9, v9, v223
  v_cvt_pk_bf16_f32 v239, v222, v223
  ds_read_b128 v[184:187], v22 offset:24576
  ds_read_b128 v[188:191], v23 offset:24576
  ds_read_b128 v[208:211], v30 offset:384
  ds_read_b128 v[212:215], v30 offset:416
  ds_read_b128 v[216:219], v30 offset:448
  ds_read_b128 v[220:223], v30 offset:480
  v_mfma_f32_32x32x16_bf16 v[144:159], v[228:231], v[60:63], v[144:159]
  v_exp_f32 v192, v192
  v_exp_f32 v193, v193
  v_add_f32 v8, v8, v192
  s_waitcnt lgkmcnt(0)
  v_mfma_f32_32x32x16_bf16 v[208:223], v[160:163], v[64:67], v[208:223]
  ds_read_b128 v[4:7], v29
  v_exp_f32 v194, v194
  v_add_f32 v9, v9, v193
  v_cvt_pk_bf16_f32 v240, v192, v193
  v_mfma_f32_32x32x16_bf16 v[208:223], v[164:167], v[68:71], v[208:223]
  v_exp_f32 v195, v195
  v_add_f32 v8, v8, v194
  v_exp_f32 v196, v196
  v_add_f32 v9, v9, v195
  v_mfma_f32_32x32x16_bf16 v[208:223], v[168:171], v[72:75], v[208:223]
  s_waitcnt lgkmcnt(0)
  v_min_u32 v4, v4, v5
  v_min3_u32 v4, v4, v6, v7
  s_nop 0
  v_readfirstlane_b32 s60, v4
  v_cvt_pk_bf16_f32 v241, v194, v195
  v_exp_f32 v197, v197
  v_mfma_f32_32x32x16_bf16 v[208:223], v[172:175], v[76:79], v[208:223]
  s_cmp_lt_u32 s60, 12
  s_cbranch_scc1 L_pp27
L_ppd28:
  ds_read_b64_tr_b16 v[32:33], v24 offset:8192
  ds_read_b64_tr_b16 v[34:35], v24 offset:10240
  ds_read_b64_tr_b16 v[36:37], v25 offset:8192
  ds_read_b64_tr_b16 v[38:39], v25 offset:10240
  v_add_f32 v8, v8, v196
  v_exp_f32 v198, v198
  v_add_f32 v9, v9, v197
  v_mfma_f32_32x32x16_bf16 v[208:223], v[176:179], v[80:83], v[208:223]
  ds_read_b64_tr_b16 v[40:41], v26 offset:8192
  ds_read_b64_tr_b16 v[42:43], v26 offset:10240
  ds_read_b64_tr_b16 v[44:45], v27 offset:8192
  ds_read_b64_tr_b16 v[46:47], v27 offset:10240
  v_cvt_pk_bf16_f32 v242, v196, v197
  v_exp_f32 v199, v199
  v_add_f32 v8, v8, v198
  v_mfma_f32_32x32x16_bf16 v[208:223], v[180:183], v[84:87], v[208:223]
  ds_read_b64_tr_b16 v[48:49], v24 offset:12288
  ds_read_b64_tr_b16 v[50:51], v24 offset:14336
  ds_read_b64_tr_b16 v[52:53], v25 offset:12288
  ds_read_b64_tr_b16 v[54:55], v25 offset:14336
  v_exp_f32 v200, v200
  v_add_f32 v9, v9, v199
  v_cvt_pk_bf16_f32 v243, v198, v199
  v_mfma_f32_32x32x16_bf16 v[208:223], v[184:187], v[88:91], v[208:223]
  ds_read_b64_tr_b16 v[56:57], v26 offset:12288
  ds_read_b64_tr_b16 v[58:59], v26 offset:14336
  ds_read_b64_tr_b16 v[60:61], v27 offset:12288
  ds_read_b64_tr_b16 v[62:63], v27 offset:14336
  v_exp_f32 v201, v201
  v_add_f32 v8, v8, v200
  v_mfma_f32_32x32x16_bf16 v[208:223], v[188:191], v[92:95], v[208:223]
  v_exp_f32 v202, v202
  v_add_f32 v9, v9, v201
  v_cvt_pk_bf16_f32 v244, v200, v201
  v_exp_f32 v203, v203
  s_cmp_eq_u32 s3, 0
  s_cbranch_scc1 L_go
L_god:
  s_waitcnt lgkmcnt(14)
  v_mfma_f32_32x32x16_bf16 v[96:111], v[232:235], v[32:35], v[96:111]
  ds_read_b128 v[4:7], v29
  v_add_f32 v8, v8, v202
  v_exp_f32 v204, v204
  v_add_f32 v9, v9, v203
  v_cvt_pk_bf16_f32 v245, v202, v203
  s_waitcnt lgkmcnt(13)
  v_mfma_f32_32x32x16_bf16 v[112:127], v[232:235], v[36:39], v[112:127]
  v_exp_f32 v205, v205
  v_add_f32 v8, v8, v204
  v_exp_f32 v206, v206
  v_add_f32 v9, v9, v205
  s_waitcnt lgkmcnt(11)
  v_mfma_f32_32x32x16_bf16 v[128:143], v[232:235], v[40:43], v[128:143]
  s_waitcnt lgkmcnt(0)
  v_min_u32 v4, v4, v5
  v_min3_u32 v4, v4, v6, v7
  s_nop 0
  v_readfirstlane_b32 s60, v4
  v_cvt_pk_bf16_f32 v246, v204, v205
  v_exp_f32 v207, v207
  v_mfma_f32_32x32x16_bf16 v[144:159], v[232:235], v[44:47], v[144:159]
  s_cmp_lt_u32 s60, 14
  s_cbranch_scc1 L_pp29
L_ppd30:
  ds_read_b128 v[160:163], v16 offset:32768
  ds_read_b128 v[164:167], v17 offset:32768
  v_add_f32 v8, v8, v206
  v_add_f32 v9, v9, v207
  v_cvt_pk_bf16_f32 v247, v206, v207
  v_mfma_f32_32x32x16_bf16 v[96:111], v[236:239], v[48:51], v[96:111]
  ds_read_b128 v[168:171], v18 offset:32768
  ds_read_b128 v[172:175], v19 offset:32768
  v_exp_f32 v208, v208
  v_exp_f32 v209, v209
  v_mfma_f32_32x32x16_bf16 v[112:127], v[236:239], v[52:55], v[112:127]
  ds_read_b128 v[176:179], v20 offset:32768
  ds_read_b128 v[180:183], v21 offset:32768
  v_add_f32 v8, v8, v208
  v_exp_f32 v210, v210
  v_add_f32 v9, v9, v209
  v_mfma_f32_32x32x16_bf16 v[128:143], v[236:239], v[56:59], v[128:143]
  ds_read_b128 v[184:187], v22 offset:32768
  ds_read_b128 v[188:191], v23 offset:32768
  ds_read_b128 v[192:195], v30 offset:512
  ds_read_b128 v[196:199], v30 offset:544
  ds_read_b128 v[200:203], v30 offset:576
  ds_read_b128 v[204:207], v30 offset:608
  v_mfma_f32_32x32x16_bf16 v[144:159], v[236:239], v[60:63], v[144:159]
  v_cvt_pk_bf16_f32 v248, v208, v209
  v_exp_f32 v211, v211
  v_add_f32 v8, v8, v210
  v_exp_f32 v212, v212
  s_waitcnt lgkmcnt(0)
  v_mfma_f32_32x32x16_bf16 v[192:207], v[160:163], v[64:67], v[192:207]
  ds_read_b128 v[4:7], v29
  v_add_f32 v9, v9, v211
  v_cvt_pk_bf16_f32 v249, v210, v211
  v_exp_f32 v213, v213
  v_add_f32 v8, v8, v212
  v_mfma_f32_32x32x16_bf16 v[192:207], v[164:167], v[68:71], v[192:207]
  v_exp_f32 v214, v214
  v_add_f32 v9, v9, v213
  v_cvt_pk_bf16_f32 v250, v212, v213
  v_exp_f32 v215, v215
  v_mfma_f32_32x32x16_bf16 v[192:207], v[168:171], v[72:75], v[192:207]
  s_waitcnt lgkmcnt(0)
  v_min_u32 v4, v4, v5
  v_min3_u32 v4, v4, v6, v7
  s_nop 0
  v_readfirstlane_b32 s60, v4
  v_add_f32 v8, v8, v214
  v_exp_f32 v216, v216
  v_mfma_f32_32x32x16_bf16 v[192:207], v[172:175], v[76:79], v[192:207]
  s_cmp_lt_u32 s60, 15
  s_cbranch_scc1 L_pp31
L_ppd32:
  ds_read_b64_tr_b16 v[32:33], v24 offset:16384
  ds_read_b64_tr_b16 v[34:35], v24 offset:18432
  ds_read_b64_tr_b16 v[36:37], v25 offset:16384
  ds_read_b64_tr_b16 v[38:39], v25 offset:18432
  v_add_f32 v9, v9, v215
  v_cvt_pk_bf16_f32 v251, v214, v215
  v_exp_f32 v217, v217
  v_mfma_f32_32x32x16_bf16 v[192:207], v[176:179], v[80:83], v[192:207]
  ds_read_b64_tr_b16 v[40:41], v26 offset:16384
  ds_read_b64_tr_b16 v[42:43], v26 offset:18432
  ds_read_b64_tr_b16 v[44:45], v27 offset:16384
  ds_read_b64_tr_b16 v[46:47], v27 offset:18432
  v_add_f32 v8, v8, v216
  v_exp_f32 v218, v218
  v_add_f32 v9, v9, v217
  v_mfma_f32_32x32x16_bf16 v[192:207], v[180:183], v[84:87], v[192:207]
  ds_read_b64_tr_b16 v[48:49], v24 offset:20480
  ds_read_b64_tr_b16 v[50:51], v24 offset:22528
  ds_read_b64_tr_b16 v[52:53], v25 offset:20480
  ds_read_b64_tr_b16 v[54:55], v25 offset:22528
  v_cvt_pk_bf16_f32 v252, v216, v217
  v_exp_f32 v219, v219
  v_add_f32 v8, v8, v218
  v_mfma_f32_32x32x16_bf16 v[192:207], v[184:187], v[88:91], v[192:207]
  ds_read_b64_tr_b16 v[56:57], v26 offset:20480
  ds_read_b64_tr_b16 v[58:59], v26 offset:22528
  ds_read_b64_tr_b16 v[60:61], v27 offset:20480
  ds_read_b64_tr_b16 v[62:63], v27 offset:22528
  v_exp_f32 v220, v220
  v_add_f32 v9, v9, v219
  v_cvt_pk_bf16_f32 v253, v218, v219
  v_mfma_f32_32x32x16_bf16 v[192:207], v[188:191], v[92:95], v[192:207]
  v_exp_f32 v221, v221
  v_add_f32 v8, v8, v220
  v_exp_f32 v222, v222
  v_add_f32 v9, v9, v221
  v_mov_b32 v1, 3
  s_mov_b64 exec, 1
  ds_write_b32 v31, v1 offset:0
  s_mov_b64 exec, -1
  s_waitcnt lgkmcnt(15)
  v_mfma_f32_32x32x16_bf16 v[96:111], v[240:243], v[32:35], v[96:111]
  ds_read_b128 v[4:7], v29
  v_cvt_pk_bf16_f32 v254, v220, v221
  v_exp_f32 v223, v223
  v_add_f32 v8, v8, v222
  v_add_f32 v9, v9, v223
  s_waitcnt lgkmcnt(14)
  v_mfma_f32_32x32x16_bf16 v[112:127], v[240:243], v[36:39], v[112:127]
  v_cvt_pk_bf16_f32 v255, v222, v223
  v_exp_f32 v192, v192
  v_exp_f32 v193, v193
  v_add_f32 v8, v8, v192
  s_waitcnt lgkmcnt(12)
  v_mfma_f32_32x32x16_bf16 v[128:143], v[240:243], v[40:43], v[128:143]
  s_waitcnt lgkmcnt(0)
  v_min_u32 v4, v4, v5
  v_min3_u32 v4, v4, v6, v7
  s_nop 0
  v_readfirstlane_b32 s60, v4
  v_exp_f32 v194, v194
  v_add_f32 v9, v9, v193
  v_mfma_f32_32x32x16_bf16 v[144:159], v[240:243], v[44:47], v[144:159]
  s_cmp_lt_u32 s60, 17
  s_cbranch_scc1 L_pp33
L_ppd34:
  ds_read_b128 v[160:163], v16 offset:40960
  ds_read_b128 v[164:167], v17 offset:40960
  v_cvt_pk_bf16_f32 v224, v192, v193
  v_exp_f32 v195, v195
  v_add_f32 v8, v8, v194
  v_mfma_f32_32x32x16_bf16 v[96:111], v[244:247], v[48:51], v[96:111]
  ds_read_b128 v[168:171], v18 offset:40960
  ds_read_b128 v[172:175], v19 offset:40960
  v_exp_f32 v196, v196
  v_add_f32 v9, v9, v195
  v_cvt_pk_bf16_f32 v225, v194, v195
  v_mfma_f32_32x32x16_bf16 v[112:127], v[244:247], v[52:55], v[112:127]
  ds_read_b128 v[176:179], v20 offset:40960
  ds_read_b128 v[180:183], v21 offset:40960
  v_exp_f32 v197, v197
  v_add_f32 v8, v8, v196
  v_mfma_f32_32x32x16_bf16 v[128:143], v[244:247], v[56:59], v[128:143]
  ds_read_b128 v[184:187], v22 offset:40960
  ds_read_b128 v[188:191], v23 offset:40960
  ds_read_b128 v[208:211], v30 offset:640
  ds_read_b128 v[212:215], v30 offset:672
  ds_read_b128 v[216:219], v30 offset:704
  ds_read_b128 v[220:223], v30 offset:736
  v_mfma_f32_32x32x16_bf16 v[144:159], v[244:247], v[60:63], v[144:159]
  v_exp_f32 v198, v198
  v_add_f32 v9, v9, v197
  v_cvt_pk_bf16_f32 v226, v196, v197
  v_exp_f32 v199, v199
  s_waitcnt lgkmcnt(0)
  v_mfma_f32_32x32x16_bf16 v[208:223], v[160:163], v[64:67], v[208:223]
  ds_read_b128 v[4:7], v29
  v_add_f32 v8, v8, v198
  v_exp_f32 v200, v200
  v_add_f32 v9, v9, v199
  v_cvt_pk_bf16_f32 v227, v198, v199
  v_mfma_f32_32x32x16_bf16 v[208:223], v[164:167], v[68:71], v[208:223]
  v_exp_f32 v201, v201
  v_add_f32 v8, v8, v200
  v_exp_f32 v202, v202
  v_add_f32 v9, v9, v201
  v_mfma_f32_32x32x16_bf16 v[208:223], v[168:171], v[72:75], v[208:223]
  s_waitcnt lgkmcnt(0)
  v_min_u32 v4, v4, v5
  v_min3_u32 v4, v4, v6, v7
  s_nop 0
  v_readfirstlane_b32 s60, v4
  v_cvt_pk_bf16_f32 v228, v200, v201
  v_exp_f32 v203, v203
  v_mfma_f32_32x32x16_bf16 v[208:223], v[172:175], v[76:79], v[208:223]
  s_cmp_lt_u32 s60, 18
  s_cbranch_scc1 L_pp35
L_ppd36:
  ds_read_b64_tr_b16 v[32:33], v24 offset:24576
  ds_read_b64_tr_b16 v[34:35], v24 offset:26624
  ds_read_b64_tr_b16 v[36:37], v25 offset:24576
  ds_read_b64_tr_b16 v[38:39], v25 offset:26624
  v_add_f32 v8, v8, v202
  v_exp_f32 v204, v204
  v_add_f32 v9, v9, v203
  v_mfma_f32_32x32x16_bf16 v[208:223], v[176:179], v[80:83], v[208:223]
  ds_read_b64_tr_b16 v[40:41], v26 offset:24576
  ds_read_b64_tr_b16 v[42:43], v26 offset:26624
  ds_read_b64_tr_b16 v[44:45], v27 offset:24576
  ds_read_b64_tr_b16 v[46:47], v27 offset:26624
  v_cvt_pk_bf16_f32 v229, v202, v203
  v_exp_f32 v205, v205
  v_add_f32 v8, v8, v204
  v_mfma_f32_32x32x16_bf16 v[208:223], v[180:183], v[84:87], v[208:223]
  ds_read_b64_tr_b16 v[48:49], v24 offset:28672
  ds_read_b64_tr_b16 v[50:51], v24 offset:30720
  ds_read_b64_tr_b16 v[52:53], v25 offset:28672
  ds_read_b64_tr_b16 v[54:55], v25 offset:30720
  v_exp_f32 v206, v206
  v_add_f32 v9, v9, v205
  v_cvt_pk_bf16_f32 v230, v204, v205
  v_mfma_f32_32x32x16_bf16 v[208:223], v[184:187], v[88:91], v[208:223]
  ds_read_b64_tr_b16 v[56:57], v26 offset:28672
  ds_read_b64_tr_b16 v[58:59], v26 offset:30720
  ds_read_b64_tr_b16 v[60:61], v27 offset:28672
  ds_read_b64_tr_b16 v[62:63], v27 offset:30720
  v_exp_f32 v207, v207
  v_add_f32 v8, v8, v206
  v_add_f32 v9, v9, v207
  v_mfma_f32_32x32x16_bf16 v[208:223], v[188:191], v[92:95], v[208:223]
  v_cvt_pk_bf16_f32 v231, v206, v207
  buffer_load_dword v3, off, s[36:39], s66 sc1
  s_waitcnt lgkmcnt(14)
  v_mfma_f32_32x32x16_bf16 v[96:111], v[248:251], v[32:35], v[96:111]
  ds_read_b128 v[4:7], v29
  s_waitcnt lgkmcnt(13)
  v_mfma_f32_32x32x16_bf16 v[112:127], v[248:251], v[36:39], v[112:127]
  s_nop 4
  v_exp_f32 v208, v208
  v_exp_f32 v209, v209
  v_add_f32 v8, v8, v208
  s_waitcnt lgkmcnt(11)
  v_mfma_f32_32x32x16_bf16 v[128:143], v[248:251], v[40:43], v[128:143]
  s_waitcnt lgkmcnt(0)
  v_min_u32 v4, v4, v5
  v_min3_u32 v4, v4, v6, v7
  s_nop 0
  v_readfirstlane_b32 s60, v4
  v_exp_f32 v210, v210
  v_add_f32 v9, v9, v209
  v_mfma_f32_32x32x16_bf16 v[144:159], v[248:251], v[44:47], v[144:159]
  s_cmp_lt_u32 s60, 20
  s_cbranch_scc1 L_pp37
L_ppd38:
  ds_read_b128 v[160:163], v16 offset:49152
  ds_read_b128 v[164:167], v17 offset:49152
  v_cvt_pk_bf16_f32 v232, v208, v209
  v_exp_f32 v211, v211
  v_add_f32 v8, v8, v210
  v_mfma_f32_32x32x16_bf16 v[96:111], v[252:255], v[48:51], v[96:111]
  ds_read_b128 v[168:171], v18 offset:49152
  ds_read_b128 v[172:175], v19 offset:49152
  v_exp_f32 v212, v212
  v_add_f32 v9, v9, v211
  v_cvt_pk_bf16_f32 v233, v210, v211
  v_mfma_f32_32x32x16_bf16 v[112:127], v[252:255], v[52:55], v[112:127]
  ds_read_b128 v[176:179], v20 offset:49152
  ds_read_b128 v[180:183], v21 offset:49152
  v_exp_f32 v213, v213
  v_add_f32 v8, v8, v212
  v_mfma_f32_32x32x16_bf16 v[128:143], v[252:255], v[56:59], v[128:143]
  ds_read_b128 v[184:187], v22 offset:49152
  ds_read_b128 v[188:191], v23 offset:49152
  ds_read_b128 v[192:195], v30 offset:768
  ds_read_b128 v[196:199], v30 offset:800
  ds_read_b128 v[200:203], v30 offset:832
  ds_read_b128 v[204:207], v30 offset:864
  v_mfma_f32_32x32x16_bf16 v[144:159], v[252:255], v[60:63], v[144:159]
  v_exp_f32 v214, v214
  v_add_f32 v9, v9, v213
  v_cvt_pk_bf16_f32 v234, v212, v213
  v_exp_f32 v215, v215
  s_waitcnt lgkmcnt(0)
  v_mfma_f32_32x32x16_bf16 v[192:207], v[160:163], v[64:67], v[192:207]
  ds_read_b128 v[4:7], v29
  v_add_f32 v8, v8, v214
  v_exp_f32 v216, v216
  v_add_f32 v9, v9, v215
  v_cvt_pk_bf16_f32 v235, v214, v215
  v_mfma_f32_32x32x16_bf16 v[192:207], v[164:167], v[68:71], v[192:207]
  v_exp_f32 v217, v217
  v_add_f32 v8, v8, v216
  v_exp_f32 v218, v218
  v_add_f32 v9, v9, v217
  v_mfma_f32_32x32x16_bf16 v[192:207], v[168:171], v[72:75], v[192:207]
  s_waitcnt lgkmcnt(0)
  v_min_u32 v4, v4, v5
  v_min3_u32 v4, v4, v6, v7
  s_nop 0
  v_readfirstlane_b32 s60, v4
  v_cvt_pk_bf16_f32 v236, v216, v217
  v_exp_f32 v219, v219
  v_mfma_f32_32x32x16_bf16 v[192:207], v[172:175], v[76:79], v[192:207]
  s_cmp_lt_u32 s60, 21
  s_cbranch_scc1 L_pp39
L_ppd40:
  ds_read_b64_tr_b16 v[32:33], v24 offset:32768
  ds_read_b64_tr_b16 v[34:35], v24 offset:34816
  ds_read_b64_tr_b16 v[36:37], v25 offset:32768
  ds_read_b64_tr_b16 v[38:39], v25 offset:34816
  v_add_f32 v8, v8, v218
  v_exp_f32 v220, v220
  v_add_f32 v9, v9, v219
  v_mfma_f32_32x32x16_bf16 v[192:207], v[176:179], v[80:83], v[192:207]
  ds_read_b64_tr_b16 v[40:41], v26 offset:32768
  ds_read_b64_tr_b16 v[42:43], v26 offset:34816
  ds_read_b64_tr_b16 v[44:45], v27 offset:32768
  ds_read_b64_tr_b16 v[46:47], v27 offset:34816
  v_cvt_pk_bf16_f32 v237, v218, v219
  v_exp_f32 v221, v221
  v_add_f32 v8, v8, v220
  v_mfma_f32_32x32x16_bf16 v[192:207], v[180:183], v[84:87], v[192:207]
  ds_read_b64_tr_b16 v[48:49], v24 offset:36864
  ds_read_b64_tr_b16 v[50:51], v24 offset:38912
  ds_read_b64_tr_b16 v[52:53], v25 offset:36864
  ds_read_b64_tr_b16 v[54:55], v25 offset:38912
  v_exp_f32 v222, v222
  v_add_f32 v9, v9, v221
  v_cvt_pk_bf16_f32 v238, v220, v221
  v_mfma_f32_32x32x16_bf16 v[192:207], v[184:187], v[88:91], v[192:207]
  ds_read_b64_tr_b16 v[56:57], v26 offset:36864
  ds_read_b64_tr_b16 v[58:59], v26 offset:38912
  ds_read_b64_tr_b16 v[60:61], v27 offset:36864
  ds_read_b64_tr_b16 v[62:63], v27 offset:38912
  v_exp_f32 v223, v223
  v_add_f32 v8, v8, v222
  v_add_f32 v9, v9, v223
  v_mfma_f32_32x32x16_bf16 v[192:207], v[188:191], v[92:95], v[192:207]
  v_cvt_pk_bf16_f32 v239, v222, v223
  v_mov_b32 v1, 4
  s_mov_b64 exec, 1
  ds_write_b32 v31, v1 offset:0
  s_mov_b64 exec, -1
  s_waitcnt lgkmcnt(15)
  v_mfma_f32_32x32x16_bf16 v[96:111], v[224:227], v[32:35], v[96:111]
  ds_read_b128 v[4:7], v29
  s_waitcnt lgkmcnt(14)
  v_mfma_f32_32x32x16_bf16 v[112:127], v[224:227], v[36:39], v[112:127]
  s_nop 1
  v_exp_f32 v192, v192
  v_exp_f32 v193, v193
  v_add_f32 v8, v8, v192
  s_waitcnt lgkmcnt(12)
  v_mfma_f32_32x32x16_bf16 v[128:143], v[224:227], v[40:43], v[128:143]
  s_waitcnt lgkmcnt(0)
  v_min_u32 v4, v4, v5
  v_min3_u32 v4, v4, v6, v7
  s_nop 0
  v_readfirstlane_b32 s60, v4
  v_exp_f32 v194, v194
  v_add_f32 v9, v9, v193
  v_mfma_f32_32x32x16_bf16 v[144:159], v[224:227], v[44:47], v[144:159]
  s_cmp_lt_u32 s60, 23
  s_cbranch_scc1 L_pp41
L_ppd42:
  ds_read_b128 v[160:163], v16 offset:0
  ds_read_b128 v[164:167], v17 offset:0
  v_cvt_pk_bf16_f32 v240, v192, v193
  v_exp_f32 v195, v195
  v_add_f32 v8, v8, v194
  v_mfma_f32_32x32x16_bf16 v[96:111], v[228:231], v[48:51], v[96:111]
  ds_read_b128 v[168:171], v18 offset:0
  ds_read_b128 v[172:175], v19 offset:0
  v_exp_f32 v196, v196
  v_add_f32 v9, v9, v195
  v_cvt_pk_bf16_f32 v241, v194, v195
  v_mfma_f32_32x32x16_bf16 v[112:127], v[228:231], v[52:55], v[112:127]
  ds_read_b128 v[176:179], v20 offset:0
  ds_read_b128 v[180:183], v21 offset:0
  v_exp_f32 v197, v197
  v_add_f32 v8, v8, v196
  v_mfma_f32_32x32x16_bf16 v[128:143], v[228:231], v[56:59], v[128:143]
  ds_read_b128 v[184:187], v22 offset:0
  ds_read_b128 v[188:191], v23 offset:0
  ds_read_b128 v[208:211], v30 offset:896
  ds_read_b128 v[212:215], v30 offset:928
  ds_read_b128 v[216:219], v30 offset:960
  ds_read_b128 v[220:223], v30 offset:992
  v_mfma_f32_32x32x16_bf16 v[144:159], v[228:231], v[60:63], v[144:159]
  v_exp_f32 v198, v198
  v_add_f32 v9, v9, v197
  v_cvt_pk_bf16_f32 v242, v196, v197
  v_exp_f32 v199, v199
  s_waitcnt lgkmcnt(0)
  v_mfma_f32_32x32x16_bf16 v[208:223], v[160:163], v[64:67], v[208:223]
  ds_read_b128 v[4:7], v29
  v_add_f32 v8, v8, v198
  v_exp_f32 v200, v200
  v_add_f32 v9, v9, v199
  v_cvt_pk_bf16_f32 v243, v198, v199
  v_mfma_f32_32x32x16_bf16 v[208:223], v[164:167], v[68:71], v[208:223]
  v_exp_f32 v201, v201
  v_add_f32 v8, v8, v200
  v_exp_f32 v202, v202
  v_add_f32 v9, v9, v201
  v_mfma_f32_32x32x16_bf16 v[208:223], v[168:171], v[72:75], v[208:223]
  s_waitcnt lgkmcnt(0)
  v_min_u32 v4, v4, v5
  v_min3_u32 v4, v4, v6, v7
  s_nop 0
  v_readfirstlane_b32 s60, v4
  v_cvt_pk_bf16_f32 v244, v200, v201
  v_exp_f32 v203, v203
  v_mfma_f32_32x32x16_bf16 v[208:223], v[172:175], v[76:79], v[208:223]
  s_cmp_lt_u32 s60, 24
  s_cbranch_scc1 L_pp43
L_ppd44:
  ds_read_b64_tr_b16 v[32:33], v24 offset:40960
  ds_read_b64_tr_b16 v[34:35], v24 offset:43008
  ds_read_b64_tr_b16 v[36:37], v25 offset:40960
  ds_read_b64_tr_b16 v[38:39], v25 offset:43008
  v_add_f32 v8, v8, v202
  v_exp_f32 v204, v204
  v_add_f32 v9, v9, v203
  v_mfma_f32_32x32x16_bf16 v[208:223], v[176:179], v[80:83], v[208:223]
  ds_read_b64_tr_b16 v[40:41], v26 offset:40960
  ds_read_b64_tr_b16 v[42:43], v26 offset:43008
  ds_read_b64_tr_b16 v[44:45], v27 offset:40960
  ds_read_b64_tr_b16 v[46:47], v27 offset:43008
  v_cvt_pk_bf16_f32 v245, v202, v203
  v_exp_f32 v205, v205
  v_add_f32 v8, v8, v204
  v_mfma_f32_32x32x16_bf16 v[208:223], v[180:183], v[84:87], v[208:223]
  ds_read_b64_tr_b16 v[48:49], v24 offset:45056
  ds_read_b64_tr_b16 v[50:51], v24 offset:47104
  ds_read_b64_tr_b16 v[52:53], v25 offset:45056
  ds_read_b64_tr_b16 v[54:55], v25 offset:47104
  v_exp_f32 v206, v206
  v_add_f32 v9, v9, v205
  v_cvt_pk_bf16_f32 v246, v204, v205
  v_mfma_f32_32x32x16_bf16 v[208:223], v[184:187], v[88:91], v[208:223]
  ds_read_b64_tr_b16 v[56:57], v26 offset:45056
  ds_read_b64_tr_b16 v[58:59], v26 offset:47104
  ds_read_b64_tr_b16 v[60:61], v27 offset:45056
  ds_read_b64_tr_b16 v[62:63], v27 offset:47104
  v_exp_f32 v207, v207
  v_add_f32 v8, v8, v206
  v_add_f32 v9, v9, v207
  v_mfma_f32_32x32x16_bf16 v[208:223], v[188:191], v[92:95], v[208:223]
  v_cvt_pk_bf16_f32 v247, v206, v207
  s_waitcnt lgkmcnt(14)
  v_mfma_f32_32x32x16_bf16 v[96:111], v[232:235], v[32:35], v[96:111]
  ds_read_b128 v[4:7], v29
  s_waitcnt lgkmcnt(13)
  v_mfma_f32_32x32x16_bf16 v[112:127], v[232:235], v[36:39], v[112:127]
  s_nop 5
  v_exp_f32 v208, v208
  v_exp_f32 v209, v209
  v_add_f32 v8, v8, v208
  s_waitcnt lgkmcnt(11)
  v_mfma_f32_32x32x16_bf16 v[128:143], v[232:235], v[40:43], v[128:143]
  s_waitcnt lgkmcnt(0)
  v_min_u32 v4, v4, v5
  v_min3_u32 v4, v4, v6, v7
  s_nop 0
  v_readfirstlane_b32 s60, v4
  v_exp_f32 v210, v210
  v_add_f32 v9, v9, v209
  v_mfma_f32_32x32x16_bf16 v[144:159], v[232:235], v[44:47], v[144:159]
  s_cmp_lt_u32 s60, 26
  s_cbranch_scc1 L_pp45
L_ppd46:
  ds_read_b64_tr_b16 v[160:161], v24 offset:49152
  ds_read_b64_tr_b16 v[162:163], v24 offset:51200
  ds_read_b64_tr_b16 v[164:165], v25 offset:49152
  ds_read_b64_tr_b16 v[166:167], v25 offset:51200
  v_cvt_pk_bf16_f32 v248, v208, v209
  v_exp_f32 v211, v211
  v_add_f32 v8, v8, v210
  v_mfma_f32_32x32x16_bf16 v[96:111], v[236:239], v[48:51], v[96:111]
  ds_read_b64_tr_b16 v[168:169], v26 offset:49152
  ds_read_b64_tr_b16 v[170:171], v26 offset:51200
  ds_read_b64_tr_b16 v[172:173], v27 offset:49152
  ds_read_b64_tr_b16 v[174:175], v27 offset:51200
  v_exp_f32 v212, v212
  v_add_f32 v9, v9, v211
  v_cvt_pk_bf16_f32 v249, v210, v211
  v_mfma_f32_32x32x16_bf16 v[112:127], v[236:239], v[52:55], v[112:127]
  ds_read_b64_tr_b16 v[176:177], v24 offset:53248
  ds_read_b64_tr_b16 v[178:179], v24 offset:55296
  ds_read_b64_tr_b16 v[180:181], v25 offset:53248
  ds_read_b64_tr_b16 v[182:183], v25 offset:55296
  v_exp_f32 v213, v213
  v_add_f32 v8, v8, v212
  v_mfma_f32_32x32x16_bf16 v[128:143], v[236:239], v[56:59], v[128:143]
  ds_read_b64_tr_b16 v[184:185], v26 offset:53248
  ds_read_b64_tr_b16 v[186:187], v26 offset:55296
  ds_read_b64_tr_b16 v[188:189], v27 offset:53248
  ds_read_b64_tr_b16 v[190:191], v27 offset:55296
  v_exp_f32 v214, v214
  v_add_f32 v9, v9, v213
  v_cvt_pk_bf16_f32 v250, v212, v213
  v_mfma_f32_32x32x16_bf16 v[144:159], v[236:239], v[60:63], v[144:159]
  v_exp_f32 v215, v215
  v_add_f32 v8, v8, v214
  v_exp_f32 v216, v216
  v_add_f32 v9, v9, v215
  s_waitcnt lgkmcnt(14)
  v_mfma_f32_32x32x16_bf16 v[96:111], v[240:243], v[160:163], v[96:111]
  ds_read_b128 v[4:7], v29
  v_cvt_pk_bf16_f32 v251, v214, v215
  v_exp_f32 v217, v217
  v_add_f32 v8, v8, v216
  s_waitcnt lgkmcnt(13)
  v_mfma_f32_32x32x16_bf16 v[112:127], v[240:243], v[164:167], v[112:127]
  v_exp_f32 v218, v218
  v_add_f32 v9, v9, v217
  v_cvt_pk_bf16_f32 v252, v216, v217
  v_exp_f32 v219, v219
  s_waitcnt lgkmcnt(11)
  v_mfma_f32_32x32x16_bf16 v[128:143], v[240:243], v[168:171], v[128:143]
  s_waitcnt lgkmcnt(0)
  v_min_u32 v4, v4, v5
  v_min3_u32 v4, v4, v6, v7
  s_nop 0
  v_readfirstlane_b32 s60, v4
  v_add_f32 v8, v8, v218
  v_exp_f32 v220, v220
  v_mfma_f32_32x32x16_bf16 v[144:159], v[240:243], v[172:175], v[144:159]
  v_add_f32 v9, v9, v219
  v_cvt_pk_bf16_f32 v253, v218, v219
  v_exp_f32 v221, v221
  v_add_f32 v8, v8, v220
  v_mfma_f32_32x32x16_bf16 v[96:111], v[244:247], v[176:179], v[96:111]
  v_exp_f32 v222, v222
  v_add_f32 v9, v9, v221
  v_cvt_pk_bf16_f32 v254, v220, v221
  v_exp_f32 v223, v223
  v_mfma_f32_32x32x16_bf16 v[112:127], v[244:247], v[180:183], v[112:127]
  v_add_f32 v8, v8, v222
  v_add_f32 v9, v9, v223
  v_cvt_pk_bf16_f32 v255, v222, v223
  v_mfma_f32_32x32x16_bf16 v[128:143], v[244:247], v[184:187], v[128:143]
  v_mfma_f32_32x32x16_bf16 v[144:159], v[244:247], v[188:191], v[144:159]
  v_add_f32 v12, v8, v9
  v_mov_b32 v13, v12
  v_and_b32 v14, 31, v2
  v_lshlrev_b32 v14, 5, v14
  v_permlane32_swap_b32 v12, v13
  v_add_f32 v12, v12, v13
L_hs:
  s_waitcnt vmcnt(0)
  v_readfirstlane_b32 s57, v3
  s_nop 0
  s_cmp_eq_u32 s57, 0
  s_cbranch_scc1 L_hsagain
L_hsd:
  s_cmp_eq_u32 s57, 1
  s_cbranch_scc0 L_slow
  s_mov_b32 exec_hi, 0
  buffer_store_dword v12, v14, s[36:39], s53 offen
  s_mov_b32 exec_hi, -1
  v_mov_b32 v192, -1
  v_mov_b32 v193, -1
  v_mov_b32 v194, -1
  v_mov_b32 v195, -1
  buffer_store_dwordx4 v[192:195], v28, s[36:39], s100 offen
  s_cmp_lt_u32 s60, 28
  s_cbranch_scc1 L_pp47
L_ppd48:
  ds_read_b64_tr_b16 v[32:33], v24 offset:57344
  ds_read_b64_tr_b16 v[34:35], v24 offset:59392
  ds_read_b64_tr_b16 v[48:49], v24 offset:61440
  ds_read_b64_tr_b16 v[50:51], v24 offset:63488
  ds_read_b64_tr_b16 v[36:37], v25 offset:57344
  ds_read_b64_tr_b16 v[38:39], v25 offset:59392
  ds_read_b64_tr_b16 v[52:53], v25 offset:61440
  ds_read_b64_tr_b16 v[54:55], v25 offset:63488
  ds_read_b64_tr_b16 v[40:41], v26 offset:57344
  ds_read_b64_tr_b16 v[42:43], v26 offset:59392
  ds_read_b64_tr_b16 v[56:57], v26 offset:61440
  ds_read_b64_tr_b16 v[58:59], v26 offset:63488
  s_waitcnt lgkmcnt(10)
  v_mfma_f32_32x32x16_bf16 v[96:111], v[248:251], v[32:35], v[96:111]
  ds_read_b64_tr_b16 v[44:45], v27 offset:57344
  ds_read_b64_tr_b16 v[46:47], v27 offset:59392
  ds_read_b64_tr_b16 v[60:61], v27 offset:61440
  ds_read_b64_tr_b16 v[62:63], v27 offset:63488
  s_waitcnt lgkmcnt(12)
  v_mfma_f32_32x32x16_bf16 v[96:111], v[252:255], v[48:51], v[96:111]
  s_waitcnt lgkmcnt(10)
  v_mfma_f32_32x32x16_bf16 v[112:127], v[248:251], v[36:39], v[112:127]
  s_waitcnt lgkmcnt(8)
  v_mfma_f32_32x32x16_bf16 v[112:127], v[252:255], v[52:55], v[112:127]
  s_waitcnt lgkmcnt(6)
  v_mfma_f32_32x32x16_bf16 v[128:143], v[248:251], v[40:43], v[128:143]
  s_cmp_eq_u32 s49, 0
  s_cbranch_scc1 L_st49
  s_nop 3
  v_cvt_pk_bf16_f32 v208, v96, v97
  v_cvt_pk_bf16_f32 v209, v98, v99
  v_cvt_pk_bf16_f32 v210, v100, v101
  v_cvt_pk_bf16_f32 v211, v102, v103
  buffer_store_dwordx4 v[208:211], v28, s[36:39], s98 offen
L_sn50:
  s_add_u32 s98, s98, 32768
  s_cmp_eq_u32 s49, 1
  s_cbranch_scc1 L_st51
  v_cvt_pk_bf16_f32 v212, v104, v105
  v_cvt_pk_bf16_f32 v213, v106, v107
  v_cvt_pk_bf16_f32 v214, v108, v109
  v_cvt_pk_bf16_f32 v215, v110, v111
  buffer_store_dwordx4 v[212:215], v28, s[36:39], s98 offen
L_sn52:
  s_add_u32 s98, s98, 32768
  s_waitcnt lgkmcnt(4)
  v_mfma_f32_32x32x16_bf16 v[128:143], v[252:255], v[56:59], v[128:143]
  s_waitcnt lgkmcnt(2)
  v_mfma_f32_32x32x16_bf16 v[144:159], v[248:251], v[44:47], v[144:159]
  s_cmp_eq_u32 s49, 2
  s_cbranch_scc1 L_st53
  v_cvt_pk_bf16_f32 v216, v112, v113
  v_cvt_pk_bf16_f32 v217, v114, v115
  v_cvt_pk_bf16_f32 v218, v116, v117
  v_cvt_pk_bf16_f32 v219, v118, v119
  buffer_store_dwordx4 v[216:219], v28, s[36:39], s98 offen
L_sn54:
  s_add_u32 s98, s98, 32768
  s_cmp_eq_u32 s49, 3
  s_cbranch_scc1 L_st55
  v_cvt_pk_bf16_f32 v220, v120, v121
  v_cvt_pk_bf16_f32 v221, v122, v123
  v_cvt_pk_bf16_f32 v222, v124, v125
  v_cvt_pk_bf16_f32 v223, v126, v127
  buffer_store_dwordx4 v[220:223], v28, s[36:39], s98 offen
L_sn56:
  s_add_u32 s98, s98, 32768
  s_waitcnt lgkmcnt(0)
  v_mfma_f32_32x32x16_bf16 v[144:159], v[252:255], v[60:63], v[144:159]
  s_cmp_eq_u32 s49, 4
  s_cbranch_scc1 L_st57
  v_cvt_pk_bf16_f32 v208, v128, v129
  v_cvt_pk_bf16_f32 v209, v130, v131
  v_cvt_pk_bf16_f32 v210, v132, v133
  v_cvt_pk_bf16_f32 v211, v134, v135
  buffer_store_dwordx4 v[208:211], v28, s[36:39], s98 offen
L_sn58:
  s_add_u32 s98, s98, 32768
  s_cmp_eq_u32 s49, 5
  s_cbranch_scc1 L_st59
  v_cvt_pk_bf16_f32 v212, v136, v137
  v_cvt_pk_bf16_f32 v213, v138, v139
  v_cvt_pk_bf16_f32 v214, v140, v141
  v_cvt_pk_bf16_f32 v215, v142, v143
  buffer_store_dwordx4 v[212:215], v28, s[36:39], s98 offen
L_sn60:
  s_add_u32 s98, s98, 32768
  s_cmp_eq_u32 s49, 6
  s_cbranch_scc1 L_st61
  v_cvt_pk_bf16_f32 v216, v144, v145
  v_cvt_pk_bf16_f32 v217, v146, v147
  v_cvt_pk_bf16_f32 v218, v148, v149
  v_cvt_pk_bf16_f32 v219, v150, v151
  buffer_store_dwordx4 v[216:219], v28, s[36:39], s98 offen
L_sn62:
  s_add_u32 s98, s98, 32768
  s_cmp_eq_u32 s49, 7
  s_cbranch_scc1 L_st63
  v_cvt_pk_bf16_f32 v220, v152, v153
  v_cvt_pk_bf16_f32 v221, v154, v155
  v_cvt_pk_bf16_f32 v222, v156, v157
  v_cvt_pk_bf16_f32 v223, v158, v159
  buffer_store_dwordx4 v[220:223], v28, s[36:39], s98 offen
L_sn64:
  s_add_u32 s98, s98, 32768
  v_mov_b32 v232, 0x3f80
  v_mov_b32 v233, 0x3f800000
  v_mov_b32 v7, 1
  v_lshrrev_b32 v6, 5, v2
  v_lshl_add_u32 v6, v6, 4, v14
  v_lshrrev_b32 v3, 5, v2
  v_lshlrev_b32 v10, 4, v3
  v_add_u32 v10, 155904, v10
  v_and_b32 v4, 31, v2
  v_and_b32 v5, 7, v2
  v_and_b32 v8, 1, v2
  v_lshl_add_u32 v5, v8, 3, v5
  v_lshlrev_b32 v5, 4, v5
  v_lshl_add_u32 v5, v4, 8, v5
  v_lshl_add_u32 v5, v3, 3, v5
  s_lshl_b32 s62, s3, 13
  s_add_u32 s57, s62, 32768
  v_add_u32 v240, s57, v5
  v_xor_b32 v241, 16, v240
  v_xor_b32 v242, 32, v240
  v_xor_b32 v243, 48, v240
  v_xor_b32 v244, 64, v240
  v_xor_b32 v245, 80, v240
  v_xor_b32 v246, 96, v240
  v_xor_b32 v247, 112, v240
  v_lshrrev_b32 v3, 3, v2
  v_and_b32 v4, 7, v2
  v_xor_b32 v5, v4, v3
  v_and_b32 v8, 1, v3
  v_lshl_add_u32 v5, v8, 3, v5
  v_lshlrev_b32 v5, 4, v5
  v_lshl_add_u32 v5, v3, 8, v5
  v_add_u32 v12, s57, v5
  v_xor_b32 v13, 128, v12
  v_lshlrev_b32 v4, 4, v4
  v_lshl_add_u32 v14, v3, 8, v4
  s_add_u32 s62, s62, s19
  s_and_b32 s62, s62, 0xffff
  s_add_u32 s62, s62, s18
  s_add_u32 s61, s62, 4096
  v_add_u32 v16, s57, v28
  s_lshl_b32 s57, s3, 11
  v_add_u32 v15, s57, v28
  s_mov_b64 exec, 1
  s_waitcnt vmcnt(0)
  buffer_store_dword v7, off, s[36:39], s59
  s_mov_b64 exec, -1
  s_add_u32 s4, s49, 1
  s_and_b32 s4, s4, 7
  s_lshl_b32 s4, s4, 10
  s_add_u32 s4, s4, s99
  s_add_u32 s5, s49, 2
  s_and_b32 s5, s5, 7
  s_lshl_b32 s5, s5, 10
  s_add_u32 s5, s5, s99
  s_add_u32 s6, s49, 3
  s_and_b32 s6, s6, 7
  s_lshl_b32 s6, s6, 10
  s_add_u32 s6, s6, s99
  s_add_u32 s7, s49, 4
  s_and_b32 s7, s7, 7
  s_lshl_b32 s7, s7, 10
  s_add_u32 s7, s7, s99
  s_add_u32 s8, s49, 5
  s_and_b32 s8, s8, 7
  s_lshl_b32 s8, s8, 10
  s_add_u32 s8, s8, s99
  s_add_u32 s9, s49, 6
  s_and_b32 s9, s9, 7
  s_lshl_b32 s9, s9, 10
  s_add_u32 s9, s9, s99
  s_add_u32 s10, s49, 7
  s_and_b32 s10, s10, 7
  s_lshl_b32 s10, s10, 10
  s_add_u32 s10, s10, s99
  v_bfe_u32 v3, v2, 4, 1
  v_lshlrev_b32 v3, 5, v3
  v_bfe_u32 v4, v2, 2, 1
  v_lshl_add_u32 v3, v4, 4, v3
  v_bfe_u32 v4, v2, 3, 1
  v_lshl_add_u32 v3, v4, 3, v3
  v_and_b32 v4, 3, v2
  v_lshl_add_u32 v3, v4, 1, v3
  s_lshl_b32 s57, s3, 6
  s_add_u32 s57, s57, 155904
  v_add_u32 v3, s57, v3
  s_add_u32 s58, s51, 4096
L_gp65:
  buffer_load_dword v250, v11, s[36:39], s63 offen offset:0 sc1
  s_sub_u32 s69, s69, 1
  s_cbranch_scc1 L_gpd66
  s_waitcnt vmcnt(0)
  v_cmp_ne_u32 vcc, 1, v250
  s_nop 0
  s_cmp_lg_u64 vcc, 0
  s_cbranch_scc1 L_gp65
L_gpd66:
  buffer_load_dwordx4 v[160:163], v28, s[36:39], s4 offen sc1
  buffer_load_dwordx4 v[164:167], v28, s[36:39], s5 offen sc1
  buffer_load_dwordx4 v[168:171], v28, s[36:39], s6 offen sc1
  buffer_load_dwordx4 v[172:175], v28, s[36:39], s7 offen sc1
  buffer_load_dwordx4 v[176:179], v28, s[36:39], s8 offen sc1
  buffer_load_dwordx4 v[180:183], v28, s[36:39], s9 offen sc1
  buffer_load_dwordx4 v[184:187], v28, s[36:39], s10 offen sc1
  buffer_load_dwordx4 v[200:203], v6, s[36:39], s52 offen sc1
  s_waitcnt vmcnt(7)
  v_dot2_f32_bf16 v224, v160, v232, v224
  v_dot2_f32_bf16 v225, v160, v233, v225
  v_dot2_f32_bf16 v226, v161, v232, v226
  v_dot2_f32_bf16 v227, v161, v233, v227
  v_dot2_f32_bf16 v228, v162, v232, v228
  v_dot2_f32_bf16 v229, v162, v233, v229
  v_dot2_f32_bf16 v230, v163, v232, v230
  v_dot2_f32_bf16 v231, v163, v233, v231
  s_waitcnt vmcnt(6)
  v_dot2_f32_bf16 v224, v164, v232, v224
  v_dot2_f32_bf16 v225, v164, v233, v225
  v_dot2_f32_bf16 v226, v165, v232, v226
  v_dot2_f32_bf16 v227, v165, v233, v227
  v_dot2_f32_bf16 v228, v166, v232, v228
  v_dot2_f32_bf16 v229, v166, v233, v229
  v_dot2_f32_bf16 v230, v167, v232, v230
  v_dot2_f32_bf16 v231, v167, v233, v231
  s_waitcnt vmcnt(5)
  v_dot2_f32_bf16 v224, v168, v232, v224
  v_dot2_f32_bf16 v225, v168, v233, v225
  v_dot2_f32_bf16 v226, v169, v232, v226
  v_dot2_f32_bf16 v227, v169, v233, v227
  v_dot2_f32_bf16 v228, v170, v232, v228
  v_dot2_f32_bf16 v229, v170, v233, v229
  v_dot2_f32_bf16 v230, v171, v232, v230
  v_dot2_f32_bf16 v231, v171, v233, v231
  s_waitcnt vmcnt(4)
  v_dot2_f32_bf16 v224, v172, v232, v224
  v_dot2_f32_bf16 v225, v172, v233, v225
  v_dot2_f32_bf16 v226, v173, v232, v226
  v_dot2_f32_bf16 v227, v173, v233, v227
  v_dot2_f32_bf16 v228, v174, v232, v228
  v_dot2_f32_bf16 v229, v174, v233, v229
  v_dot2_f32_bf16 v230, v175, v232, v230
  v_dot2_f32_bf16 v231, v175, v233, v231
  s_waitcnt vmcnt(3)
  v_dot2_f32_bf16 v224, v176, v232, v224
  v_dot2_f32_bf16 v225, v176, v233, v225
  v_dot2_f32_bf16 v226, v177, v232, v226
  v_dot2_f32_bf16 v227, v177, v233, v227
  v_dot2_f32_bf16 v228, v178, v232, v228
  v_dot2_f32_bf16 v229, v178, v233, v229
  v_dot2_f32_bf16 v230, v179, v232, v230
  v_dot2_f32_bf16 v231, v179, v233, v231
  s_waitcnt vmcnt(2)
  v_dot2_f32_bf16 v224, v180, v232, v224
  v_dot2_f32_bf16 v225, v180, v233, v225
  v_dot2_f32_bf16 v226, v181, v232, v226
  v_dot2_f32_bf16 v227, v181, v233, v227
  v_dot2_f32_bf16 v228, v182, v232, v228
  v_dot2_f32_bf16 v229, v182, v233, v229
  v_dot2_f32_bf16 v230, v183, v232, v230
  v_dot2_f32_bf16 v231, v183, v233, v231
  s_waitcnt vmcnt(1)
  v_dot2_f32_bf16 v224, v184, v232, v224
  v_dot2_f32_bf16 v225, v184, v233, v225
  v_dot2_f32_bf16 v226, v185, v232, v226
  v_dot2_f32_bf16 v227, v185, v233, v227
  v_dot2_f32_bf16 v228, v186, v232, v228
  v_dot2_f32_bf16 v229, v186, v233, v229
  v_dot2_f32_bf16 v230, v187, v232, v230
  v_dot2_f32_bf16 v231, v187, v233, v231
  v_cvt_pk_bf16_f32 v208, v224, v225
  v_cvt_pk_bf16_f32 v209, v226, v227
  v_cvt_pk_bf16_f32 v210, v228, v229
  v_cvt_pk_bf16_f32 v211, v230, v231
  v_min_u32 v208, -2, v208
  v_min_u32 v209, -2, v209
  v_min_u32 v210, -2, v210
  v_min_u32 v211, -2, v211
  buffer_store_dwordx4 v[208:211], v28, s[36:39], s100 offen
  s_waitcnt vmcnt(1)
  v_add_f32 v200, v200, v201
  v_add_f32 v202, v202, v203
  v_add_f32 v200, v200, v202
  v_mov_b32 v201, v200
  s_nop 1
  v_permlane32_swap_b32 v200, v201
  v_add_f32 v200, v200, v201
  v_cvt_pk_bf16_f32 v200, v200, v200
  s_mov_b32 exec_hi, 0
  ds_write_b16 v3, v200
  s_mov_b32 exec_hi, -1
  s_waitcnt lgkmcnt(0)
  s_barrier
  ds_read_b128 v[32:35], v16 offset:0
  ds_read_b128 v[36:39], v16 offset:1024
  ds_read_b128 v[40:43], v16 offset:2048
  ds_read_b128 v[44:47], v16 offset:3072
  ds_read_b128 v[48:51], v16 offset:4096
  ds_read_b128 v[52:55], v16 offset:5120
  ds_read_b128 v[56:59], v16 offset:6144
  ds_read_b128 v[60:63], v16 offset:7168
  ds_read_b128 v[64:67], v10 offset:0
  ds_read_b128 v[68:71], v10 offset:32
  ds_read_b128 v[72:75], v10 offset:64
  ds_read_b128 v[76:79], v10 offset:96
  ds_read_b128 v[80:83], v10 offset:128
  ds_read_b128 v[84:87], v10 offset:160
  ds_read_b128 v[88:91], v10 offset:192
  s_waitcnt lgkmcnt(7)
  ds_read_b128 v[92:95], v10 offset:224
  s_waitcnt lgkmcnt(7)
  v_dot2_f32_bf16 v4, v32, v64, 0
  v_dot2_f32_bf16 v5, v33, v65, 0
  v_dot2_f32_bf16 v4, v34, v66, v4
  v_dot2_f32_bf16 v5, v35, v67, v5
  s_waitcnt lgkmcnt(6)
  v_dot2_f32_bf16 v4, v36, v68, v4
  v_dot2_f32_bf16 v5, v37, v69, v5
  v_dot2_f32_bf16 v4, v38, v70, v4
  v_dot2_f32_bf16 v5, v39, v71, v5
  s_waitcnt lgkmcnt(5)
  v_dot2_f32_bf16 v4, v40, v72, v4
  v_dot2_f32_bf16 v5, v41, v73, v5
  v_dot2_f32_bf16 v4, v42, v74, v4
  v_dot2_f32_bf16 v5, v43, v75, v5
  s_waitcnt lgkmcnt(4)
  v_dot2_f32_bf16 v4, v44, v76, v4
  v_dot2_f32_bf16 v5, v45, v77, v5
  v_dot2_f32_bf16 v4, v46, v78, v4
  v_dot2_f32_bf16 v5, v47, v79, v5
  s_waitcnt lgkmcnt(3)
  v_dot2_f32_bf16 v4, v48, v80, v4
  v_dot2_f32_bf16 v5, v49, v81, v5
  v_dot2_f32_bf16 v4, v50, v82, v4
  v_dot2_f32_bf16 v5, v51, v83, v5
  s_waitcnt lgkmcnt(2)
  v_dot2_f32_bf16 v4, v52, v84, v4
  v_dot2_f32_bf16 v5, v53, v85, v5
  v_dot2_f32_bf16 v4, v54, v86, v4
  v_dot2_f32_bf16 v5, v55, v87, v5
  s_waitcnt lgkmcnt(1)
  v_dot2_f32_bf16 v4, v56, v88, v4
  v_dot2_f32_bf16 v5, v57, v89, v5
  v_dot2_f32_bf16 v4, v58, v90, v4
  v_dot2_f32_bf16 v5, v59, v91, v5
  s_waitcnt lgkmcnt(0)
  v_dot2_f32_bf16 v4, v60, v92, v4
  v_dot2_f32_bf16 v5, v61, v93, v5
  v_dot2_f32_bf16 v4, v62, v94, v4
  v_dot2_f32_bf16 v5, v63, v95, v5
  s_nop 2
  v_add_f32 v4, v4, v5
  v_mov_b32 v5, v4
  s_nop 1
  v_permlane32_swap_b32 v4, v5
  v_add_f32 v4, v4, v5
  v_add_f32 v4, 0x358637bd, v4
  v_rcp_f32 v8, v4
L_fp67:
  buffer_load_dwordx4 v[160:163], v28, s[36:39], s51 offen offset:0 sc1
  buffer_load_dwordx4 v[164:167], v28, s[36:39], s51 offen offset:1024 sc1
  buffer_load_dwordx4 v[168:171], v28, s[36:39], s51 offen offset:2048 sc1
  buffer_load_dwordx4 v[172:175], v28, s[36:39], s51 offen offset:3072 sc1
  buffer_load_dwordx4 v[176:179], v28, s[36:39], s58 offen offset:0 sc1
  buffer_load_dwordx4 v[180:183], v28, s[36:39], s58 offen offset:1024 sc1
  buffer_load_dwordx4 v[184:187], v28, s[36:39], s58 offen offset:2048 sc1
  buffer_load_dwordx4 v[188:191], v28, s[36:39], s58 offen offset:3072 sc1
  s_sub_u32 s69, s69, 1
  s_cbranch_scc1 L_fpd68
  s_waitcnt vmcnt(6)
  v_max3_u32 v216, v160, v161, v162
  v_max3_u32 v217, v163, v164, v165
  v_max3_u32 v216, v166, v167, v216
  s_waitcnt vmcnt(4)
  v_max3_u32 v216, v168, v169, v216
  v_max3_u32 v217, v170, v171, v217
  v_max3_u32 v216, v172, v173, v216
  v_max3_u32 v217, v174, v175, v217
  s_waitcnt vmcnt(2)
  v_max3_u32 v216, v176, v177, v216
  v_max3_u32 v217, v178, v179, v217
  v_max3_u32 v216, v180, v181, v216
  v_max3_u32 v217, v182, v183, v217
  s_waitcnt vmcnt(0)
  v_max3_u32 v216, v184, v185, v216
  v_max3_u32 v217, v186, v187, v217
  v_max3_u32 v216, v188, v189, v216
  v_max3_u32 v217, v190, v191, v217
  v_max_u32 v216, v216, v217
  v_cmp_eq_u32 vcc, -1, v216
  s_nop 0
  s_cmp_lg_u64 vcc, 0
  s_cbranch_scc1 L_fp67
L_fpd68:
L_join:
  s_waitcnt vmcnt(7)
  ds_write_b128 v15, v[160:163] offset:0
  s_waitcnt vmcnt(6)
  ds_write_b128 v15, v[164:167] offset:1024
  s_waitcnt vmcnt(5)
  ds_write_b128 v15, v[168:171] offset:8192
  s_waitcnt vmcnt(4)
  ds_write_b128 v15, v[172:175] offset:9216
  s_waitcnt vmcnt(3)
  ds_write_b128 v15, v[176:179] offset:16384
  s_waitcnt vmcnt(2)
  ds_write_b128 v15, v[180:183] offset:17408
  s_waitcnt vmcnt(1)
  ds_write_b128 v15, v[184:187] offset:24576
  s_waitcnt vmcnt(0)
  ds_write_b128 v15, v[188:191] offset:25600
  s_waitcnt lgkmcnt(0)
  s_barrier
  ds_read_b128 v[96:99], v28 offset:0
  ds_read_b128 v[100:103], v28 offset:1024
  ds_read_b128 v[104:107], v28 offset:2048
  ds_read_b128 v[108:111], v28 offset:3072
  ds_read_b128 v[112:115], v28 offset:4096
  ds_read_b128 v[116:119], v28 offset:5120
  ds_read_b128 v[120:123], v28 offset:6144
  ds_read_b128 v[124:127], v28 offset:7168
L_out:
  s_waitcnt lgkmcnt(7)
  v_mfma_f32_32x32x16_bf16 v[192:207], v[96:99], v[32:35], 0
  ds_read_b128 v[128:131], v28 offset:8192
  s_waitcnt lgkmcnt(7)
  v_mfma_f32_32x32x16_bf16 v[192:207], v[100:103], v[36:39], v[192:207]
  ds_read_b128 v[132:135], v28 offset:9216
  s_waitcnt lgkmcnt(7)
  v_mfma_f32_32x32x16_bf16 v[192:207], v[104:107], v[40:43], v[192:207]
  ds_read_b128 v[136:139], v28 offset:10240
  s_waitcnt lgkmcnt(7)
  v_mfma_f32_32x32x16_bf16 v[192:207], v[108:111], v[44:47], v[192:207]
  ds_read_b128 v[140:143], v28 offset:11264
  s_waitcnt lgkmcnt(7)
  v_mfma_f32_32x32x16_bf16 v[192:207], v[112:115], v[48:51], v[192:207]
  ds_read_b128 v[144:147], v28 offset:12288
  s_waitcnt lgkmcnt(7)
  v_mfma_f32_32x32x16_bf16 v[192:207], v[116:119], v[52:55], v[192:207]
  ds_read_b128 v[148:151], v28 offset:13312
  s_waitcnt lgkmcnt(7)
  v_mfma_f32_32x32x16_bf16 v[192:207], v[120:123], v[56:59], v[192:207]
  ds_read_b128 v[152:155], v28 offset:14336
  s_waitcnt lgkmcnt(7)
  v_mfma_f32_32x32x16_bf16 v[192:207], v[124:127], v[60:63], v[192:207]
  ds_read_b128 v[156:159], v28 offset:15360
  s_waitcnt lgkmcnt(7)
  v_mfma_f32_32x32x16_bf16 v[208:223], v[128:131], v[32:35], 0
  ds_read_b128 v[96:99], v28 offset:16384
  s_waitcnt lgkmcnt(7)
  v_mfma_f32_32x32x16_bf16 v[208:223], v[132:135], v[36:39], v[208:223]
  ds_read_b128 v[100:103], v28 offset:17408
  s_nop 4
  v_mul_f32 v192, v8, v192
  v_mul_f32 v193, v8, v193
  v_mul_f32 v194, v8, v194
  v_mul_f32 v195, v8, v195
  v_cvt_pk_bf16_f32 v224, v192, v193
  s_waitcnt lgkmcnt(7)
  v_mfma_f32_32x32x16_bf16 v[208:223], v[136:139], v[40:43], v[208:223]
  ds_read_b128 v[104:107], v28 offset:18432
  v_cvt_pk_bf16_f32 v225, v194, v195
  ds_write_b64 v240, v[224:225]
  v_mul_f32 v196, v8, v196
  v_mul_f32 v197, v8, v197
  v_mul_f32 v198, v8, v198
  s_waitcnt lgkmcnt(8)
  v_mfma_f32_32x32x16_bf16 v[208:223], v[140:143], v[44:47], v[208:223]
  ds_read_b128 v[108:111], v28 offset:19456
  v_mul_f32 v199, v8, v199
  v_cvt_pk_bf16_f32 v226, v196, v197
  v_cvt_pk_bf16_f32 v227, v198, v199
  ds_write_b64 v241, v[226:227]
  v_mul_f32 v200, v8, v200
  s_waitcnt lgkmcnt(9)
  v_mfma_f32_32x32x16_bf16 v[208:223], v[144:147], v[48:51], v[208:223]
  ds_read_b128 v[112:115], v28 offset:20480
  v_mul_f32 v201, v8, v201
  v_mul_f32 v202, v8, v202
  v_mul_f32 v203, v8, v203
  v_cvt_pk_bf16_f32 v228, v200, v201
  v_cvt_pk_bf16_f32 v229, v202, v203
  s_waitcnt lgkmcnt(9)
  v_mfma_f32_32x32x16_bf16 v[208:223], v[148:151], v[52:55], v[208:223]
  ds_read_b128 v[116:119], v28 offset:21504
  ds_write_b64 v242, v[228:229]
  v_mul_f32 v204, v8, v204
  v_mul_f32 v205, v8, v205
  v_mul_f32 v206, v8, v206
  v_mul_f32 v207, v8, v207
  s_waitcnt lgkmcnt(10)
  v_mfma_f32_32x32x16_bf16 v[208:223], v[152:155], v[56:59], v[208:223]
  ds_read_b128 v[120:123], v28 offset:22528
  v_cvt_pk_bf16_f32 v230, v204, v205
  v_cvt_pk_bf16_f32 v231, v206, v207
  ds_write_b64 v243, v[230:231]
  s_waitcnt lgkmcnt(11)
  v_mfma_f32_32x32x16_bf16 v[208:223], v[156:159], v[60:63], v[208:223]
  ds_read_b128 v[124:127], v28 offset:23552
  s_waitcnt lgkmcnt(11)
  v_mfma_f32_32x32x16_bf16 v[192:207], v[96:99], v[32:35], 0
  ds_read_b128 v[128:131], v28 offset:24576
  s_waitcnt lgkmcnt(11)
  v_mfma_f32_32x32x16_bf16 v[192:207], v[100:103], v[36:39], v[192:207]
  ds_read_b128 v[132:135], v28 offset:25600
  s_nop 4
  v_mul_f32 v208, v8, v208
  v_mul_f32 v209, v8, v209
  v_mul_f32 v210, v8, v210
  v_mul_f32 v211, v8, v211
  v_cvt_pk_bf16_f32 v232, v208, v209
  s_waitcnt lgkmcnt(11)
  v_mfma_f32_32x32x16_bf16 v[192:207], v[104:107], v[40:43], v[192:207]
  ds_read_b128 v[136:139], v28 offset:26624
  v_cvt_pk_bf16_f32 v233, v210, v211
  ds_write_b64 v244, v[232:233]
  v_mul_f32 v212, v8, v212
  v_mul_f32 v213, v8, v213
  v_mul_f32 v214, v8, v214
  s_waitcnt lgkmcnt(11)
  v_mfma_f32_32x32x16_bf16 v[192:207], v[108:111], v[44:47], v[192:207]
  ds_read_b128 v[140:143], v28 offset:27648
  v_mul_f32 v215, v8, v215
  v_cvt_pk_bf16_f32 v234, v212, v213
  v_cvt_pk_bf16_f32 v235, v214, v215
  ds_write_b64 v245, v[234:235]
  v_mul_f32 v216, v8, v216
  s_waitcnt lgkmcnt(11)
  v_mfma_f32_32x32x16_bf16 v[192:207], v[112:115], v[48:51], v[192:207]
  ds_read_b128 v[144:147], v28 offset:28672
  v_mul_f32 v217, v8, v217
  v_mul_f32 v218, v8, v218
  v_mul_f32 v219, v8, v219
  v_cvt_pk_bf16_f32 v236, v216, v217
  v_cvt_pk_bf16_f32 v237, v218, v219
  s_waitcnt lgkmcnt(11)
  v_mfma_f32_32x32x16_bf16 v[192:207], v[116:119], v[52:55], v[192:207]
  ds_read_b128 v[148:151], v28 offset:29696
  ds_write_b64 v246, v[236:237]
  v_mul_f32 v220, v8, v220
  v_mul_f32 v221, v8, v221
  v_mul_f32 v222, v8, v222
  v_mul_f32 v223, v8, v223
  s_waitcnt lgkmcnt(11)
  v_mfma_f32_32x32x16_bf16 v[192:207], v[120:123], v[56:59], v[192:207]
  ds_read_b128 v[152:155], v28 offset:30720
  v_cvt_pk_bf16_f32 v238, v220, v221
  v_cvt_pk_bf16_f32 v239, v222, v223
  ds_write_b64 v247, v[238:239]
  v_xor_b32 v240, 128, v240
  v_xor_b32 v241, 128, v241
  s_waitcnt lgkmcnt(11)
  v_mfma_f32_32x32x16_bf16 v[192:207], v[124:127], v[60:63], v[192:207]
  ds_read_b128 v[156:159], v28 offset:31744
  v_xor_b32 v242, 128, v242
  v_xor_b32 v243, 128, v243
  v_xor_b32 v244, 128, v244
  v_xor_b32 v245, 128, v245
  v_xor_b32 v246, 128, v246
  v_xor_b32 v247, 128, v247
  ds_read_b128 v[160:163], v12 offset:0
  ds_read_b128 v[164:167], v12 offset:2048
  ds_read_b128 v[168:171], v12 offset:4096
  ds_read_b128 v[172:175], v12 offset:6144
  s_waitcnt lgkmcnt(15)
  v_mfma_f32_32x32x16_bf16 v[208:223], v[128:131], v[32:35], 0
  s_waitcnt lgkmcnt(14)
  v_mfma_f32_32x32x16_bf16 v[208:223], v[132:135], v[36:39], v[208:223]
  s_waitcnt lgkmcnt(3)
  buffer_store_dwordx4 v[160:163], v14, s[32:35], s62 offen offset:0 nt
  s_waitcnt lgkmcnt(2)
  buffer_store_dwordx4 v[164:167], v14, s[32:35], s62 offen offset:2048 nt
  s_waitcnt lgkmcnt(1)
  buffer_store_dwordx4 v[168:171], v14, s[32:35], s61 offen offset:0 nt
  s_waitcnt lgkmcnt(0)
  buffer_store_dwordx4 v[172:175], v14, s[32:35], s61 offen offset:2048 nt
  v_mul_f32 v192, v8, v192
  v_mul_f32 v193, v8, v193
  v_mfma_f32_32x32x16_bf16 v[208:223], v[136:139], v[40:43], v[208:223]
  v_mul_f32 v194, v8, v194
  v_mul_f32 v195, v8, v195
  v_cvt_pk_bf16_f32 v224, v192, v193
  v_cvt_pk_bf16_f32 v225, v194, v195
  ds_write_b64 v240, v[224:225]
  v_mul_f32 v196, v8, v196
  v_mfma_f32_32x32x16_bf16 v[208:223], v[140:143], v[44:47], v[208:223]
  v_mul_f32 v197, v8, v197
  v_mul_f32 v198, v8, v198
  v_mul_f32 v199, v8, v199
  v_cvt_pk_bf16_f32 v226, v196, v197
  v_cvt_pk_bf16_f32 v227, v198, v199
  ds_write_b64 v241, v[226:227]
  v_mfma_f32_32x32x16_bf16 v[208:223], v[144:147], v[48:51], v[208:223]
  v_mul_f32 v200, v8, v200
  v_mul_f32 v201, v8, v201
  v_mul_f32 v202, v8, v202
  v_mul_f32 v203, v8, v203
  v_cvt_pk_bf16_f32 v228, v200, v201
  v_cvt_pk_bf16_f32 v229, v202, v203
  v_mfma_f32_32x32x16_bf16 v[208:223], v[148:151], v[52:55], v[208:223]
  ds_write_b64 v242, v[228:229]
  v_mul_f32 v204, v8, v204
  v_mul_f32 v205, v8, v205
  v_mul_f32 v206, v8, v206
  v_mul_f32 v207, v8, v207
  v_cvt_pk_bf16_f32 v230, v204, v205
  v_mfma_f32_32x32x16_bf16 v[208:223], v[152:155], v[56:59], v[208:223]
  v_cvt_pk_bf16_f32 v231, v206, v207
  ds_write_b64 v243, v[230:231]
  v_mfma_f32_32x32x16_bf16 v[208:223], v[156:159], v[60:63], v[208:223]
  s_nop 11
  v_mul_f32 v208, v8, v208
  v_mul_f32 v209, v8, v209
  v_mul_f32 v210, v8, v210
  v_mul_f32 v211, v8, v211
  v_cvt_pk_bf16_f32 v232, v208, v209
  v_cvt_pk_bf16_f32 v233, v210, v211
  ds_write_b64 v244, v[232:233]
  v_mul_f32 v212, v8, v212
  v_mul_f32 v213, v8, v213
  v_mul_f32 v214, v8, v214
  v_mul_f32 v215, v8, v215
  v_cvt_pk_bf16_f32 v234, v212, v213
  v_cvt_pk_bf16_f32 v235, v214, v215
  ds_write_b64 v245, v[234:235]
  v_mul_f32 v216, v8, v216
  v_mul_f32 v217, v8, v217
  v_mul_f32 v218, v8, v218
  v_mul_f32 v219, v8, v219
  v_cvt_pk_bf16_f32 v236, v216, v217
  v_cvt_pk_bf16_f32 v237, v218, v219
  ds_write_b64 v246, v[236:237]
  v_mul_f32 v220, v8, v220
  v_mul_f32 v221, v8, v221
  v_mul_f32 v222, v8, v222
  v_mul_f32 v223, v8, v223
  v_cvt_pk_bf16_f32 v238, v220, v221
  v_cvt_pk_bf16_f32 v239, v222, v223
  ds_write_b64 v247, v[238:239]
  ds_read_b128 v[176:179], v13 offset:0
  ds_read_b128 v[180:183], v13 offset:2048
  ds_read_b128 v[184:187], v13 offset:4096
  ds_read_b128 v[188:191], v13 offset:6144
  s_waitcnt lgkmcnt(3)
  buffer_store_dwordx4 v[176:179], v14, s[32:35], s62 offen offset:128 nt
  s_waitcnt lgkmcnt(2)
  buffer_store_dwordx4 v[180:183], v14, s[32:35], s62 offen offset:2176 nt
  s_waitcnt lgkmcnt(1)
  buffer_store_dwordx4 v[184:187], v14, s[32:35], s61 offen offset:128 nt
  s_waitcnt lgkmcnt(0)
  buffer_store_dwordx4 v[188:191], v14, s[32:35], s61 offen offset:2176 nt
L_end:
  s_endpgm
L_slow:
  s_mov_b32 exec_hi, 0
  buffer_store_dword v12, v14, s[36:39], s53 offen sc1
  s_mov_b32 exec_hi, -1
  v_mov_b32 v192, -1
  v_mov_b32 v193, -1
  v_mov_b32 v194, -1
  v_mov_b32 v195, -1
  buffer_store_dwordx4 v[192:195], v28, s[36:39], s100 offen sc1
  s_cmp_lt_u32 s60, 28
  s_cbranch_scc1 L_pp69
L_ppd70:
  ds_read_b64_tr_b16 v[32:33], v24 offset:57344
  ds_read_b64_tr_b16 v[34:35], v24 offset:59392
  ds_read_b64_tr_b16 v[48:49], v24 offset:61440
  ds_read_b64_tr_b16 v[50:51], v24 offset:63488
  ds_read_b64_tr_b16 v[36:37], v25 offset:57344
  ds_read_b64_tr_b16 v[38:39], v25 offset:59392
  ds_read_b64_tr_b16 v[52:53], v25 offset:61440
  ds_read_b64_tr_b16 v[54:55], v25 offset:63488
  ds_read_b64_tr_b16 v[40:41], v26 offset:57344
  ds_read_b64_tr_b16 v[42:43], v26 offset:59392
  ds_read_b64_tr_b16 v[56:57], v26 offset:61440
  ds_read_b64_tr_b16 v[58:59], v26 offset:63488
  s_waitcnt lgkmcnt(10)
  v_mfma_f32_32x32x16_bf16 v[96:111], v[248:251], v[32:35], v[96:111]
  ds_read_b64_tr_b16 v[44:45], v27 offset:57344
  ds_read_b64_tr_b16 v[46:47], v27 offset:59392
  ds_read_b64_tr_b16 v[60:61], v27 offset:61440
  ds_read_b64_tr_b16 v[62:63], v27 offset:63488
  s_waitcnt lgkmcnt(12)
  v_mfma_f32_32x32x16_bf16 v[96:111], v[252:255], v[48:51], v[96:111]
  s_waitcnt lgkmcnt(10)
  v_mfma_f32_32x32x16_bf16 v[112:127], v[248:251], v[36:39], v[112:127]
  s_waitcnt lgkmcnt(8)
  v_mfma_f32_32x32x16_bf16 v[112:127], v[252:255], v[52:55], v[112:127]
  s_waitcnt lgkmcnt(6)
  v_mfma_f32_32x32x16_bf16 v[128:143], v[248:251], v[40:43], v[128:143]
  s_cmp_eq_u32 s49, 0
  s_cbranch_scc1 L_st71
  s_nop 3
  v_cvt_pk_bf16_f32 v208, v96, v97
  v_cvt_pk_bf16_f32 v209, v98, v99
  v_cvt_pk_bf16_f32 v210, v100, v101
  v_cvt_pk_bf16_f32 v211, v102, v103
  buffer_store_dwordx4 v[208:211], v28, s[36:39], s98 offen sc1
L_sn72:
  s_add_u32 s98, s98, 32768
  s_cmp_eq_u32 s49, 1
  s_cbranch_scc1 L_st73
  v_cvt_pk_bf16_f32 v212, v104, v105
  v_cvt_pk_bf16_f32 v213, v106, v107
  v_cvt_pk_bf16_f32 v214, v108, v109
  v_cvt_pk_bf16_f32 v215, v110, v111
  buffer_store_dwordx4 v[212:215], v28, s[36:39], s98 offen sc1
L_sn74:
  s_add_u32 s98, s98, 32768
  s_waitcnt lgkmcnt(4)
  v_mfma_f32_32x32x16_bf16 v[128:143], v[252:255], v[56:59], v[128:143]
  s_waitcnt lgkmcnt(2)
  v_mfma_f32_32x32x16_bf16 v[144:159], v[248:251], v[44:47], v[144:159]
  s_cmp_eq_u32 s49, 2
  s_cbranch_scc1 L_st75
  v_cvt_pk_bf16_f32 v216, v112, v113
  v_cvt_pk_bf16_f32 v217, v114, v115
  v_cvt_pk_bf16_f32 v218, v116, v117
  v_cvt_pk_bf16_f32 v219, v118, v119
  buffer_store_dwordx4 v[216:219], v28, s[36:39], s98 offen sc1
L_sn76:
  s_add_u32 s98, s98, 32768
  s_cmp_eq_u32 s49, 3
  s_cbranch_scc1 L_st77
  v_cvt_pk_bf16_f32 v220, v120, v121
  v_cvt_pk_bf16_f32 v221, v122, v123
  v_cvt_pk_bf16_f32 v222, v124, v125
  v_cvt_pk_bf16_f32 v223, v126, v127
  buffer_store_dwordx4 v[220:223], v28, s[36:39], s98 offen sc1
L_sn78:
  s_add_u32 s98, s98, 32768
  s_waitcnt lgkmcnt(0)
  v_mfma_f32_32x32x16_bf16 v[144:159], v[252:255], v[60:63], v[144:159]
  s_cmp_eq_u32 s49, 4
  s_cbranch_scc1 L_st79
  v_cvt_pk_bf16_f32 v208, v128, v129
  v_cvt_pk_bf16_f32 v209, v130, v131
  v_cvt_pk_bf16_f32 v210, v132, v133
  v_cvt_pk_bf16_f32 v211, v134, v135
  buffer_store_dwordx4 v[208:211], v28, s[36:39], s98 offen sc1
L_sn80:
  s_add_u32 s98, s98, 32768
  s_cmp_eq_u32 s49, 5
  s_cbranch_scc1 L_st81
  v_cvt_pk_bf16_f32 v212, v136, v137
  v_cvt_pk_bf16_f32 v213, v138, v139
  v_cvt_pk_bf16_f32 v214, v140, v141
  v_cvt_pk_bf16_f32 v215, v142, v143
  buffer_store_dwordx4 v[212:215], v28, s[36:39], s98 offen sc1
L_sn82:
  s_add_u32 s98, s98, 32768
  s_cmp_eq_u32 s49, 6
  s_cbranch_scc1 L_st83
  v_cvt_pk_bf16_f32 v216, v144, v145
  v_cvt_pk_bf16_f32 v217, v146, v147
  v_cvt_pk_bf16_f32 v218, v148, v149
  v_cvt_pk_bf16_f32 v219, v150, v151
  buffer_store_dwordx4 v[216:219], v28, s[36:39], s98 offen sc1
L_sn84:
  s_add_u32 s98, s98, 32768
  s_cmp_eq_u32 s49, 7
  s_cbranch_scc1 L_st85
  v_cvt_pk_bf16_f32 v220, v152, v153
  v_cvt_pk_bf16_f32 v221, v154, v155
  v_cvt_pk_bf16_f32 v222, v156, v157
  v_cvt_pk_bf16_f32 v223, v158, v159
  buffer_store_dwordx4 v[220:223], v28, s[36:39], s98 offen sc1
L_sn86:
  s_add_u32 s98, s98, 32768
  v_mov_b32 v232, 0x3f80
  v_mov_b32 v233, 0x3f800000
  v_mov_b32 v7, 1
  v_lshrrev_b32 v6, 5, v2
  v_lshl_add_u32 v6, v6, 4, v14
  v_lshrrev_b32 v3, 5, v2
  v_lshlrev_b32 v10, 4, v3
  v_add_u32 v10, 155904, v10
  v_and_b32 v4, 31, v2
  v_and_b32 v5, 7, v2
  v_and_b32 v8, 1, v2
  v_lshl_add_u32 v5, v8, 3, v5
  v_lshlrev_b32 v5, 4, v5
  v_lshl_add_u32 v5, v4, 8, v5
  v_lshl_add_u32 v5, v3, 3, v5
  s_lshl_b32 s62, s3, 13
  s_add_u32 s57, s62, 32768
  v_add_u32 v240, s57, v5
  v_xor_b32 v241, 16, v240
  v_xor_b32 v242, 32, v240
  v_xor_b32 v243, 48, v240
  v_xor_b32 v244, 64, v240
  v_xor_b32 v245, 80, v240
  v_xor_b32 v246, 96, v240
  v_xor_b32 v247, 112, v240
  v_lshrrev_b32 v3, 3, v2
  v_and_b32 v4, 7, v2
  v_xor_b32 v5, v4, v3
  v_and_b32 v8, 1, v3
  v_lshl_add_u32 v5, v8, 3, v5
  v_lshlrev_b32 v5, 4, v5
  v_lshl_add_u32 v5, v3, 8, v5
  v_add_u32 v12, s57, v5
  v_xor_b32 v13, 128, v12
  v_lshlrev_b32 v4, 4, v4
  v_lshl_add_u32 v14, v3, 8, v4
  s_add_u32 s62, s62, s19
  s_and_b32 s62, s62, 0xffff
  s_add_u32 s62, s62, s18
  s_add_u32 s61, s62, 4096
  v_add_u32 v16, s57, v28
  s_lshl_b32 s57, s3, 11
  v_add_u32 v15, s57, v28
  s_mov_b64 exec, 1
  s_waitcnt vmcnt(0)
  buffer_store_dword v7, off, s[36:39], s59 sc1
  s_mov_b64 exec, -1
  s_add_u32 s4, s49, 1
  s_and_b32 s4, s4, 7
  s_lshl_b32 s4, s4, 10
  s_add_u32 s4, s4, s99
  s_add_u32 s5, s49, 2
  s_and_b32 s5, s5, 7
  s_lshl_b32 s5, s5, 10
  s_add_u32 s5, s5, s99
  s_add_u32 s6, s49, 3
  s_and_b32 s6, s6, 7
  s_lshl_b32 s6, s6, 10
  s_add_u32 s6, s6, s99
  s_add_u32 s7, s49, 4
  s_and_b32 s7, s7, 7
  s_lshl_b32 s7, s7, 10
  s_add_u32 s7, s7, s99
  s_add_u32 s8, s49, 5
  s_and_b32 s8, s8, 7
  s_lshl_b32 s8, s8, 10
  s_add_u32 s8, s8, s99
  s_add_u32 s9, s49, 6
  s_and_b32 s9, s9, 7
  s_lshl_b32 s9, s9, 10
  s_add_u32 s9, s9, s99
  s_add_u32 s10, s49, 7
  s_and_b32 s10, s10, 7
  s_lshl_b32 s10, s10, 10
  s_add_u32 s10, s10, s99
  v_bfe_u32 v3, v2, 4, 1
  v_lshlrev_b32 v3, 5, v3
  v_bfe_u32 v4, v2, 2, 1
  v_lshl_add_u32 v3, v4, 4, v3
  v_bfe_u32 v4, v2, 3, 1
  v_lshl_add_u32 v3, v4, 3, v3
  v_and_b32 v4, 3, v2
  v_lshl_add_u32 v3, v4, 1, v3
  s_lshl_b32 s57, s3, 6
  s_add_u32 s57, s57, 155904
  v_add_u32 v3, s57, v3
  s_add_u32 s58, s51, 4096
L_gp87:
  buffer_load_dword v250, v11, s[36:39], s63 offen offset:0 sc1
  s_sub_u32 s69, s69, 1
  s_cbranch_scc1 L_gpd88
  s_waitcnt vmcnt(0)
  v_cmp_ne_u32 vcc, 1, v250
  s_nop 0
  s_cmp_lg_u64 vcc, 0
  s_cbranch_scc1 L_gp87
L_gpd88:
  buffer_load_dwordx4 v[160:163], v28, s[36:39], s4 offen sc1
  buffer_load_dwordx4 v[164:167], v28, s[36:39], s5 offen sc1
  buffer_load_dwordx4 v[168:171], v28, s[36:39], s6 offen sc1
  buffer_load_dwordx4 v[172:175], v28, s[36:39], s7 offen sc1
  buffer_load_dwordx4 v[176:179], v28, s[36:39], s8 offen sc1
  buffer_load_dwordx4 v[180:183], v28, s[36:39], s9 offen sc1
  buffer_load_dwordx4 v[184:187], v28, s[36:39], s10 offen sc1
  buffer_load_dwordx4 v[200:203], v6, s[36:39], s52 offen sc1
  s_waitcnt vmcnt(7)
  v_dot2_f32_bf16 v224, v160, v232, v224
  v_dot2_f32_bf16 v225, v160, v233, v225
  v_dot2_f32_bf16 v226, v161, v232, v226
  v_dot2_f32_bf16 v227, v161, v233, v227
  v_dot2_f32_bf16 v228, v162, v232, v228
  v_dot2_f32_bf16 v229, v162, v233, v229
  v_dot2_f32_bf16 v230, v163, v232, v230
  v_dot2_f32_bf16 v231, v163, v233, v231
  s_waitcnt vmcnt(6)
  v_dot2_f32_bf16 v224, v164, v232, v224
  v_dot2_f32_bf16 v225, v164, v233, v225
  v_dot2_f32_bf16 v226, v165, v232, v226
  v_dot2_f32_bf16 v227, v165, v233, v227
  v_dot2_f32_bf16 v228, v166, v232, v228
  v_dot2_f32_bf16 v229, v166, v233, v229
  v_dot2_f32_bf16 v230, v167, v232, v230
  v_dot2_f32_bf16 v231, v167, v233, v231
  s_waitcnt vmcnt(5)
  v_dot2_f32_bf16 v224, v168, v232, v224
  v_dot2_f32_bf16 v225, v168, v233, v225
  v_dot2_f32_bf16 v226, v169, v232, v226
  v_dot2_f32_bf16 v227, v169, v233, v227
  v_dot2_f32_bf16 v228, v170, v232, v228
  v_dot2_f32_bf16 v229, v170, v233, v229
  v_dot2_f32_bf16 v230, v171, v232, v230
  v_dot2_f32_bf16 v231, v171, v233, v231
  s_waitcnt vmcnt(4)
  v_dot2_f32_bf16 v224, v172, v232, v224
  v_dot2_f32_bf16 v225, v172, v233, v225
  v_dot2_f32_bf16 v226, v173, v232, v226
  v_dot2_f32_bf16 v227, v173, v233, v227
  v_dot2_f32_bf16 v228, v174, v232, v228
  v_dot2_f32_bf16 v229, v174, v233, v229
  v_dot2_f32_bf16 v230, v175, v232, v230
  v_dot2_f32_bf16 v231, v175, v233, v231
  s_waitcnt vmcnt(3)
  v_dot2_f32_bf16 v224, v176, v232, v224
  v_dot2_f32_bf16 v225, v176, v233, v225
  v_dot2_f32_bf16 v226, v177, v232, v226
  v_dot2_f32_bf16 v227, v177, v233, v227
  v_dot2_f32_bf16 v228, v178, v232, v228
  v_dot2_f32_bf16 v229, v178, v233, v229
  v_dot2_f32_bf16 v230, v179, v232, v230
  v_dot2_f32_bf16 v231, v179, v233, v231
  s_waitcnt vmcnt(2)
  v_dot2_f32_bf16 v224, v180, v232, v224
  v_dot2_f32_bf16 v225, v180, v233, v225
  v_dot2_f32_bf16 v226, v181, v232, v226
  v_dot2_f32_bf16 v227, v181, v233, v227
  v_dot2_f32_bf16 v228, v182, v232, v228
  v_dot2_f32_bf16 v229, v182, v233, v229
  v_dot2_f32_bf16 v230, v183, v232, v230
  v_dot2_f32_bf16 v231, v183, v233, v231
  s_waitcnt vmcnt(1)
  v_dot2_f32_bf16 v224, v184, v232, v224
  v_dot2_f32_bf16 v225, v184, v233, v225
  v_dot2_f32_bf16 v226, v185, v232, v226
  v_dot2_f32_bf16 v227, v185, v233, v227
  v_dot2_f32_bf16 v228, v186, v232, v228
  v_dot2_f32_bf16 v229, v186, v233, v229
  v_dot2_f32_bf16 v230, v187, v232, v230
  v_dot2_f32_bf16 v231, v187, v233, v231
  v_cvt_pk_bf16_f32 v208, v224, v225
  v_cvt_pk_bf16_f32 v209, v226, v227
  v_cvt_pk_bf16_f32 v210, v228, v229
  v_cvt_pk_bf16_f32 v211, v230, v231
  v_min_u32 v208, -2, v208
  v_min_u32 v209, -2, v209
  v_min_u32 v210, -2, v210
  v_min_u32 v211, -2, v211
  buffer_store_dwordx4 v[208:211], v28, s[36:39], s100 offen sc1
  s_waitcnt vmcnt(1)
  v_add_f32 v200, v200, v201
  v_add_f32 v202, v202, v203
  v_add_f32 v200, v200, v202
  v_mov_b32 v201, v200
  s_nop 1
  v_permlane32_swap_b32 v200, v201
  v_add_f32 v200, v200, v201
  v_cvt_pk_bf16_f32 v200, v200, v200
  s_mov_b32 exec_hi, 0
  ds_write_b16 v3, v200
  s_mov_b32 exec_hi, -1
  s_waitcnt lgkmcnt(0)
  s_barrier
  ds_read_b128 v[32:35], v16 offset:0
  ds_read_b128 v[36:39], v16 offset:1024
  ds_read_b128 v[40:43], v16 offset:2048
  ds_read_b128 v[44:47], v16 offset:3072
  ds_read_b128 v[48:51], v16 offset:4096
  ds_read_b128 v[52:55], v16 offset:5120
  ds_read_b128 v[56:59], v16 offset:6144
  ds_read_b128 v[60:63], v16 offset:7168
  ds_read_b128 v[64:67], v10 offset:0
  ds_read_b128 v[68:71], v10 offset:32
  ds_read_b128 v[72:75], v10 offset:64
  ds_read_b128 v[76:79], v10 offset:96
  ds_read_b128 v[80:83], v10 offset:128
  ds_read_b128 v[84:87], v10 offset:160
  ds_read_b128 v[88:91], v10 offset:192
  s_waitcnt lgkmcnt(7)
  ds_read_b128 v[92:95], v10 offset:224
  s_waitcnt lgkmcnt(7)
  v_dot2_f32_bf16 v4, v32, v64, 0
  v_dot2_f32_bf16 v5, v33, v65, 0
  v_dot2_f32_bf16 v4, v34, v66, v4
  v_dot2_f32_bf16 v5, v35, v67, v5
  s_waitcnt lgkmcnt(6)
  v_dot2_f32_bf16 v4, v36, v68, v4
  v_dot2_f32_bf16 v5, v37, v69, v5
  v_dot2_f32_bf16 v4, v38, v70, v4
  v_dot2_f32_bf16 v5, v39, v71, v5
  s_waitcnt lgkmcnt(5)
  v_dot2_f32_bf16 v4, v40, v72, v4
  v_dot2_f32_bf16 v5, v41, v73, v5
  v_dot2_f32_bf16 v4, v42, v74, v4
  v_dot2_f32_bf16 v5, v43, v75, v5
  s_waitcnt lgkmcnt(4)
  v_dot2_f32_bf16 v4, v44, v76, v4
  v_dot2_f32_bf16 v5, v45, v77, v5
  v_dot2_f32_bf16 v4, v46, v78, v4
  v_dot2_f32_bf16 v5, v47, v79, v5
  s_waitcnt lgkmcnt(3)
  v_dot2_f32_bf16 v4, v48, v80, v4
  v_dot2_f32_bf16 v5, v49, v81, v5
  v_dot2_f32_bf16 v4, v50, v82, v4
  v_dot2_f32_bf16 v5, v51, v83, v5
  s_waitcnt lgkmcnt(2)
  v_dot2_f32_bf16 v4, v52, v84, v4
  v_dot2_f32_bf16 v5, v53, v85, v5
  v_dot2_f32_bf16 v4, v54, v86, v4
  v_dot2_f32_bf16 v5, v55, v87, v5
  s_waitcnt lgkmcnt(1)
  v_dot2_f32_bf16 v4, v56, v88, v4
  v_dot2_f32_bf16 v5, v57, v89, v5
  v_dot2_f32_bf16 v4, v58, v90, v4
  v_dot2_f32_bf16 v5, v59, v91, v5
  s_waitcnt lgkmcnt(0)
  v_dot2_f32_bf16 v4, v60, v92, v4
  v_dot2_f32_bf16 v5, v61, v93, v5
  v_dot2_f32_bf16 v4, v62, v94, v4
  v_dot2_f32_bf16 v5, v63, v95, v5
  s_nop 2
  v_add_f32 v4, v4, v5
  v_mov_b32 v5, v4
  s_nop 1
  v_permlane32_swap_b32 v4, v5
  v_add_f32 v4, v4, v5
  v_add_f32 v4, 0x358637bd, v4
  v_rcp_f32 v8, v4
L_fp89:
  buffer_load_dwordx4 v[160:163], v28, s[36:39], s51 offen offset:0 sc1
  buffer_load_dwordx4 v[164:167], v28, s[36:39], s51 offen offset:1024 sc1
  buffer_load_dwordx4 v[168:171], v28, s[36:39], s51 offen offset:2048 sc1
  buffer_load_dwordx4 v[172:175], v28, s[36:39], s51 offen offset:3072 sc1
  buffer_load_dwordx4 v[176:179], v28, s[36:39], s58 offen offset:0 sc1
  buffer_load_dwordx4 v[180:183], v28, s[36:39], s58 offen offset:1024 sc1
  buffer_load_dwordx4 v[184:187], v28, s[36:39], s58 offen offset:2048 sc1
  buffer_load_dwordx4 v[188:191], v28, s[36:39], s58 offen offset:3072 sc1
  s_sub_u32 s69, s69, 1
  s_cbranch_scc1 L_fpd90
  s_waitcnt vmcnt(6)
  v_max3_u32 v216, v160, v161, v162
  v_max3_u32 v217, v163, v164, v165
  v_max3_u32 v216, v166, v167, v216
  s_waitcnt vmcnt(4)
  v_max3_u32 v216, v168, v169, v216
  v_max3_u32 v217, v170, v171, v217
  v_max3_u32 v216, v172, v173, v216
  v_max3_u32 v217, v174, v175, v217
  s_waitcnt vmcnt(2)
  v_max3_u32 v216, v176, v177, v216
  v_max3_u32 v217, v178, v179, v217
  v_max3_u32 v216, v180, v181, v216
  v_max3_u32 v217, v182, v183, v217
  s_waitcnt vmcnt(0)
  v_max3_u32 v216, v184, v185, v216
  v_max3_u32 v217, v186, v187, v217
  v_max3_u32 v216, v188, v189, v216
  v_max3_u32 v217, v190, v191, v217
  v_max_u32 v216, v216, v217
  v_cmp_eq_u32 vcc, -1, v216
  s_nop 0
  s_cmp_lg_u64 vcc, 0
  s_cbranch_scc1 L_fp89
L_fpd90:
  s_branch L_join
L_pp17:
  s_nop 0
  ds_read_b128 v[4:7], v29 offset:0
  s_sub_u32 s69, s69, 1
  s_cbranch_scc1 L_ppd18
  s_waitcnt lgkmcnt(0)
  v_min_u32 v4, v4, v5
  v_min3_u32 v4, v4, v6, v7
  s_nop 0
  v_readfirstlane_b32 s60, v4
  s_nop 0
  s_cmp_lt_u32 s60, 5
  s_cbranch_scc1 L_pp17
  s_branch L_ppd18
L_pp19:
  s_nop 0
  ds_read_b128 v[4:7], v29 offset:0
  s_sub_u32 s69, s69, 1
  s_cbranch_scc1 L_ppd20
  s_waitcnt lgkmcnt(0)
  v_min_u32 v4, v4, v5
  v_min3_u32 v4, v4, v6, v7
  s_nop 0
  v_readfirstlane_b32 s60, v4
  s_nop 0
  s_cmp_lt_u32 s60, 6
  s_cbranch_scc1 L_pp19
  s_branch L_ppd20
L_pp21:
  s_nop 0
  ds_read_b128 v[4:7], v29 offset:0
  s_sub_u32 s69, s69, 1
  s_cbranch_scc1 L_ppd22
  s_waitcnt lgkmcnt(0)
  v_min_u32 v4, v4, v5
  v_min3_u32 v4, v4, v6, v7
  s_nop 0
  v_readfirstlane_b32 s60, v4
  s_nop 0
  s_cmp_lt_u32 s60, 8
  s_cbranch_scc1 L_pp21
  s_branch L_ppd22
L_pp23:
  s_nop 0
  ds_read_b128 v[4:7], v29 offset:0
  s_sub_u32 s69, s69, 1
  s_cbranch_scc1 L_ppd24
  s_waitcnt lgkmcnt(0)
  v_min_u32 v4, v4, v5
  v_min3_u32 v4, v4, v6, v7
  s_nop 0
  v_readfirstlane_b32 s60, v4
  s_nop 0
  s_cmp_lt_u32 s60, 9
  s_cbranch_scc1 L_pp23
  s_branch L_ppd24
L_pp25:
  s_nop 0
  ds_read_b128 v[4:7], v29 offset:0
  s_sub_u32 s69, s69, 1
  s_cbranch_scc1 L_ppd26
  s_waitcnt lgkmcnt(0)
  v_min_u32 v4, v4, v5
  v_min3_u32 v4, v4, v6, v7
  s_nop 0
  v_readfirstlane_b32 s60, v4
  s_nop 0
  s_cmp_lt_u32 s60, 11
  s_cbranch_scc1 L_pp25
  s_branch L_ppd26
L_pp27:
  s_nop 0
  ds_read_b128 v[4:7], v29 offset:0
  s_sub_u32 s69, s69, 1
  s_cbranch_scc1 L_ppd28
  s_waitcnt lgkmcnt(0)
  v_min_u32 v4, v4, v5
  v_min3_u32 v4, v4, v6, v7
  s_nop 0
  v_readfirstlane_b32 s60, v4
  s_nop 0
  s_cmp_lt_u32 s60, 12
  s_cbranch_scc1 L_pp27
  s_branch L_ppd28
L_pp29:
  s_nop 0
  ds_read_b128 v[4:7], v29 offset:0
  s_sub_u32 s69, s69, 1
  s_cbranch_scc1 L_ppd30
  s_waitcnt lgkmcnt(0)
  v_min_u32 v4, v4, v5
  v_min3_u32 v4, v4, v6, v7
  s_nop 0
  v_readfirstlane_b32 s60, v4
  s_nop 0
  s_cmp_lt_u32 s60, 14
  s_cbranch_scc1 L_pp29
  s_branch L_ppd30
L_pp31:
  s_nop 0
  ds_read_b128 v[4:7], v29 offset:0
  s_sub_u32 s69, s69, 1
  s_cbranch_scc1 L_ppd32
  s_waitcnt lgkmcnt(0)
  v_min_u32 v4, v4, v5
  v_min3_u32 v4, v4, v6, v7
  s_nop 0
  v_readfirstlane_b32 s60, v4
  s_nop 0
  s_cmp_lt_u32 s60, 15
  s_cbranch_scc1 L_pp31
  s_branch L_ppd32
L_pp33:
  s_nop 0
  ds_read_b128 v[4:7], v29 offset:0
  s_sub_u32 s69, s69, 1
  s_cbranch_scc1 L_ppd34
  s_waitcnt lgkmcnt(0)
  v_min_u32 v4, v4, v5
  v_min3_u32 v4, v4, v6, v7
  s_nop 0
  v_readfirstlane_b32 s60, v4
  s_nop 0
  s_cmp_lt_u32 s60, 17
  s_cbranch_scc1 L_pp33
  s_branch L_ppd34
L_pp35:
  s_nop 0
  ds_read_b128 v[4:7], v29 offset:0
  s_sub_u32 s69, s69, 1
  s_cbranch_scc1 L_ppd36
  s_waitcnt lgkmcnt(0)
  v_min_u32 v4, v4, v5
  v_min3_u32 v4, v4, v6, v7
  s_nop 0
  v_readfirstlane_b32 s60, v4
  s_nop 0
  s_cmp_lt_u32 s60, 18
  s_cbranch_scc1 L_pp35
  s_branch L_ppd36
L_pp37:
  s_nop 0
  ds_read_b128 v[4:7], v29 offset:0
  s_sub_u32 s69, s69, 1
  s_cbranch_scc1 L_ppd38
  s_waitcnt lgkmcnt(0)
  v_min_u32 v4, v4, v5
  v_min3_u32 v4, v4, v6, v7
  s_nop 0
  v_readfirstlane_b32 s60, v4
  s_nop 0
  s_cmp_lt_u32 s60, 20
  s_cbranch_scc1 L_pp37
  s_branch L_ppd38
L_pp39:
  s_nop 0
  ds_read_b128 v[4:7], v29 offset:0
  s_sub_u32 s69, s69, 1
  s_cbranch_scc1 L_ppd40
  s_waitcnt lgkmcnt(0)
  v_min_u32 v4, v4, v5
  v_min3_u32 v4, v4, v6, v7
  s_nop 0
  v_readfirstlane_b32 s60, v4
  s_nop 0
  s_cmp_lt_u32 s60, 21
  s_cbranch_scc1 L_pp39
  s_branch L_ppd40
L_pp41:
  s_nop 0
  ds_read_b128 v[4:7], v29 offset:0
  s_sub_u32 s69, s69, 1
  s_cbranch_scc1 L_ppd42
  s_waitcnt lgkmcnt(0)
  v_min_u32 v4, v4, v5
  v_min3_u32 v4, v4, v6, v7
  s_nop 0
  v_readfirstlane_b32 s60, v4
  s_nop 0
  s_cmp_lt_u32 s60, 23
  s_cbranch_scc1 L_pp41
  s_branch L_ppd42
L_pp43:
  s_nop 0
  ds_read_b128 v[4:7], v29 offset:0
  s_sub_u32 s69, s69, 1
  s_cbranch_scc1 L_ppd44
  s_waitcnt lgkmcnt(0)
  v_min_u32 v4, v4, v5
  v_min3_u32 v4, v4, v6, v7
  s_nop 0
  v_readfirstlane_b32 s60, v4
  s_nop 0
  s_cmp_lt_u32 s60, 24
  s_cbranch_scc1 L_pp43
  s_branch L_ppd44
L_pp45:
  s_nop 0
  ds_read_b128 v[4:7], v29 offset:0
  s_sub_u32 s69, s69, 1
  s_cbranch_scc1 L_ppd46
  s_waitcnt lgkmcnt(0)
  v_min_u32 v4, v4, v5
  v_min3_u32 v4, v4, v6, v7
  s_nop 0
  v_readfirstlane_b32 s60, v4
  s_nop 0
  s_cmp_lt_u32 s60, 26
  s_cbranch_scc1 L_pp45
  s_branch L_ppd46
L_go:
  s_waitcnt vmcnt(0)
  v_readfirstlane_b32 s57, v10
  s_lshl_b32 s58, 1, s64
  s_add_u32 s57, s57, s58
  s_and_b32 s58, s57, 0x0f0f0f0f
  s_lshr_b32 s61, s57, 4
  s_and_b32 s61, s61, 0x0f0f0f0f
  s_add_u32 s58, s58, s61
  s_mul_i32 s58, s58, 0x01010101
  s_lshr_b32 s58, s58, 24
  s_cmp_lg_u32 s58, 8
  s_cbranch_scc1 L_god
  s_lshl_b32 s58, 8, s64
  s_cmp_eq_u32 s57, s58
  s_cselect_b32 s57, 1, 2
  v_mov_b32 v10, s57
  s_mov_b64 exec, 0xff
  buffer_store_dword v10, v11, s[36:39], s65 offen sc1
  s_mov_b64 exec, -1
  s_branch L_god
L_hsagain:
  s_sleep 2
  s_sub_u32 s69, s69, 1
  s_cbranch_scc1 L_hsd
  buffer_load_dword v3, off, s[36:39], s66 sc1
  s_branch L_hs
L_pp47:
  s_nop 0
  ds_read_b128 v[4:7], v29 offset:0
  s_sub_u32 s69, s69, 1
  s_cbranch_scc1 L_ppd48
  s_waitcnt lgkmcnt(0)
  v_min_u32 v4, v4, v5
  v_min3_u32 v4, v4, v6, v7
  s_nop 0
  v_readfirstlane_b32 s60, v4
  s_nop 0
  s_cmp_lt_u32 s60, 28
  s_cbranch_scc1 L_pp47
  s_branch L_ppd48
L_st49:
  s_nop 11
  v_mov_b64 v[224:225], v[96:97]
  v_mov_b64 v[226:227], v[98:99]
  v_mov_b64 v[228:229], v[100:101]
  v_mov_b64 v[230:231], v[102:103]
  s_branch L_sn50
L_st51:
  s_nop 11
  v_mov_b64 v[224:225], v[104:105]
  v_mov_b64 v[226:227], v[106:107]
  v_mov_b64 v[228:229], v[108:109]
  v_mov_b64 v[230:231], v[110:111]
  s_branch L_sn52
L_st53:
  s_nop 11
  v_mov_b64 v[224:225], v[112:113]
  v_mov_b64 v[226:227], v[114:115]
  v_mov_b64 v[228:229], v[116:117]
  v_mov_b64 v[230:231], v[118:119]
  s_branch L_sn54
L_st55:
  s_nop 11
  v_mov_b64 v[224:225], v[120:121]
  v_mov_b64 v[226:227], v[122:123]
  v_mov_b64 v[228:229], v[124:125]
  v_mov_b64 v[230:231], v[126:127]
  s_branch L_sn56
L_st57:
  s_nop 11
  v_mov_b64 v[224:225], v[128:129]
  v_mov_b64 v[226:227], v[130:131]
  v_mov_b64 v[228:229], v[132:133]
  v_mov_b64 v[230:231], v[134:135]
  s_branch L_sn58
L_st59:
  s_nop 11
  v_mov_b64 v[224:225], v[136:137]
  v_mov_b64 v[226:227], v[138:139]
  v_mov_b64 v[228:229], v[140:141]
  v_mov_b64 v[230:231], v[142:143]
  s_branch L_sn60
L_st61:
  s_nop 11
  v_mov_b64 v[224:225], v[144:145]
  v_mov_b64 v[226:227], v[146:147]
  v_mov_b64 v[228:229], v[148:149]
  v_mov_b64 v[230:231], v[150:151]
  s_branch L_sn62
L_st63:
  s_nop 11
  v_mov_b64 v[224:225], v[152:153]
  v_mov_b64 v[226:227], v[154:155]
  v_mov_b64 v[228:229], v[156:157]
  v_mov_b64 v[230:231], v[158:159]
  s_branch L_sn64
L_pp69:
  s_nop 0
  ds_read_b128 v[4:7], v29 offset:0
  s_sub_u32 s69, s69, 1
  s_cbranch_scc1 L_ppd70
  s_waitcnt lgkmcnt(0)
  v_min_u32 v4, v4, v5
  v_min3_u32 v4, v4, v6, v7
  s_nop 0
  v_readfirstlane_b32 s60, v4
  s_nop 0
  s_cmp_lt_u32 s60, 28
  s_cbranch_scc1 L_pp69
  s_branch L_ppd70
L_st71:
  s_nop 11
  v_mov_b64 v[224:225], v[96:97]
  v_mov_b64 v[226:227], v[98:99]
  v_mov_b64 v[228:229], v[100:101]
  v_mov_b64 v[230:231], v[102:103]
  s_branch L_sn72
L_st73:
  s_nop 11
  v_mov_b64 v[224:225], v[104:105]
  v_mov_b64 v[226:227], v[106:107]
  v_mov_b64 v[228:229], v[108:109]
  v_mov_b64 v[230:231], v[110:111]
  s_branch L_sn74
L_st75:
  s_nop 11
  v_mov_b64 v[224:225], v[112:113]
  v_mov_b64 v[226:227], v[114:115]
  v_mov_b64 v[228:229], v[116:117]
  v_mov_b64 v[230:231], v[118:119]
  s_branch L_sn76
L_st77:
  s_nop 11
  v_mov_b64 v[224:225], v[120:121]
  v_mov_b64 v[226:227], v[122:123]
  v_mov_b64 v[228:229], v[124:125]
  v_mov_b64 v[230:231], v[126:127]
  s_branch L_sn78
L_st79:
  s_nop 11
  v_mov_b64 v[224:225], v[128:129]
  v_mov_b64 v[226:227], v[130:131]
  v_mov_b64 v[228:229], v[132:133]
  v_mov_b64 v[230:231], v[134:135]
  s_branch L_sn80
L_st81:
  s_nop 11
  v_mov_b64 v[224:225], v[136:137]
  v_mov_b64 v[226:227], v[138:139]
  v_mov_b64 v[228:229], v[140:141]
  v_mov_b64 v[230:231], v[142:143]
  s_branch L_sn82
L_st83:
  s_nop 11
  v_mov_b64 v[224:225], v[144:145]
  v_mov_b64 v[226:227], v[146:147]
  v_mov_b64 v[228:229], v[148:149]
  v_mov_b64 v[230:231], v[150:151]
  s_branch L_sn84
L_st85:
  s_nop 11
  v_mov_b64 v[224:225], v[152:153]
  v_mov_b64 v[226:227], v[154:155]
  v_mov_b64 v[228:229], v[156:157]
  v_mov_b64 v[230:231], v[158:159]
  s_branch L_sn86
L_last:
  s_endpgm
.section .rodata,"a"
.p2align 6
.amdhsa_kernel standalone__linear_kernel_performer__prompt_kernel
  .amdhsa_next_free_vgpr 256
  .amdhsa_next_free_sgpr 102
  .amdhsa_accum_offset 256
  .amdhsa_group_segment_fixed_size 0
  .amdhsa_kernarg_size 56
  .amdhsa_user_sgpr_count 2
  .amdhsa_user_sgpr_kernarg_segment_ptr 1
  .amdhsa_system_sgpr_workgroup_id_x 1
  .amdhsa_float_denorm_mode_32 3
.end_amdhsa_kernel
```
